```python
import torch

def _softmax(x, axis=-1):
    return torch.softmax(x, dim=axis)
def _gelu(x):
    return torch.nn.functional.gelu(x, approximate="tanh")
def _silu(x):
    return torch.nn.functional.silu(x)
def _sigmoid(x):
    return torch.sigmoid(x)
def _layernorm(x, axis=-1, eps=1e-5):
    m = x.mean(dim=axis, keepdim=True)
    v = x.var(dim=axis, keepdim=True, unbiased=False)
    return (x - m) / torch.sqrt(v + eps)
def _scatter_add(tgt, idx, src, axis=0):
    return tgt.clone().index_add_(axis, idx, src)
def _segment_sum(src, seg, n):
    out = torch.zeros((n,) + src.shape[1:], dtype=src.dtype)
    return out.index_add_(0, seg, src)
def _pad(x, pw):
    flat = tuple(v for pair in reversed(pw) for v in pair)
    return torch.nn.functional.pad(x, flat)

kernel_name = 'concat_heads__softmax_full_mha__ssm_conv_h3__prompt'

def setup_inputs():

    _w = (lambda a: (lambda t: t.to(torch.bfloat16) if t.is_floating_point() else t)(torch.as_tensor(a)))
    def _A_setup():
        B, S, D = 1, 2048, 576
        return {
            "x": _w((lambda *s: torch.randn(*s, dtype=torch.bfloat16) * 0.2)(B, S, D)),
            "wqkv": _w((lambda *s: torch.randn(*s, dtype=torch.bfloat16) * 0.2)(D, 3 * D)),
            "wo": _w((lambda *s: torch.randn(*s, dtype=torch.bfloat16) * 0.05)(D, D)),
        }
    _A_in = _A_setup()

    def _B_setup():
        B, S, D = 1, 2048, 576
        ks = 4
        return {
            "q": _w((lambda *s: torch.randn(*s, dtype=torch.bfloat16) * 0.05)(B, S, D)),
            "k": _w((lambda *s: torch.randn(*s, dtype=torch.bfloat16) * 0.4)(B, S, D)),
            "v": _w((lambda *s: torch.randn(*s, dtype=torch.bfloat16) * 0.4)(B, S, D)),
            "shift_k": _w((lambda *s: torch.randn(*s, dtype=torch.bfloat16) * 0.4)(D, ks) * 0.5),
            "ssm_k": _w((lambda *s: torch.randn(*s, dtype=torch.bfloat16) * 1.6)(D, S) * (1.0 / S ** 0.5)),
            "ssm_D": _w((lambda *s: torch.randn(*s, dtype=torch.bfloat16) * 0.4)(D)),
        }
    _B_in = _B_setup()

    return {
        "A_x": _A_in["x"],
        "A_wqkv": _A_in["wqkv"],
        "A_wo": _A_in["wo"],
        "B_q": _B_in["q"],
        "B_k": _B_in["k"],
        "B_v": _B_in["v"],
        "B_shift_k": _B_in["shift_k"],
        "B_ssm_k": _B_in["ssm_k"],
        "B_ssm_D": _B_in["ssm_D"],
    }

def reference(A_x, A_wqkv, A_wo, B_q, B_k, B_v, B_shift_k, B_ssm_k, B_ssm_D):
    def _A_ref(x, wqkv, wo):
        B, S, D = x.shape
        H = 32; Dh = D // H
        qkv = (lambda x, *d: x.permute(*d))((x @ wqkv).reshape(B, S, 3, H, Dh), 2, 0, 3, 1, 4)
        q, k, v = qkv[0], qkv[1], qkv[2]
        scale = Dh ** -0.5
        scores = torch.einsum("bhqd,bhkd->bhqk", q, k) * scale
        p = _softmax(scores, axis=-1)
        o = torch.einsum("bhqk,bhkd->bhqd", p, v)
        return (lambda x, *d: x.permute(*d))(o, 0, 2, 1, 3).reshape(B, S, D) @ wo

    def _B_ref(q, k, v, shift_k, ssm_k, ssm_D):
        B, S, D = q.shape
        ks = shift_k.shape[-1]
        k_pad = _pad(k, ((0, 0), (ks - 1, 0), (0, 0)))
        k_shift = torch.zeros_like(k)
        for t in range(ks):
            k_shift = k_shift + k_pad[:, t:t + S, :] * shift_k[:, ks - 1 - t][None, None, :]
        kv = k_shift * v
        L = 2 * S
        kv_pad = _pad(kv, ((0, 0), (0, S), (0, 0)))
        kf_pad = _pad(ssm_k, ((0, 0), (0, S)))
        kv_f = (lambda x, axes=(-2,-1): torch.fft.rfft2(x.float(), dim=axes))(kv_pad[:, None, :, :], axes=(1, 2))
        kf_f = (lambda x, axes=(-2,-1): torch.fft.rfft2(x.float(), dim=axes))(kf_pad[:, None, :], axes=(1, 2))
        kf_f = (lambda x, *d: x.permute(*d))(kf_f, 1, 2, 0)
        y_f = kv_f * kf_f[None, :, :, :]
        y = (lambda x, s, axes=(-2,-1): torch.fft.irfft2(x, s=s, dim=axes).to(torch.bfloat16))(y_f, (1, L), axes=(1, 2))[:, 0, :S, :]
        y = y + kv * ssm_D[None, None, :]
        return q * y

    a = _A_ref(A_x, A_wqkv, A_wo)
    b = _B_ref(B_q, B_k, B_v, B_shift_k, B_ssm_k, B_ssm_D)
    return torch.concatenate([a, b], axis=-1)
```

```asm
; @launch grid=(256,1,1) block=(512,1,1) lds=163840
.amdgcn_target "amdgcn-amd-amdhsa--gfx950"
.text
.globl concat_heads__softmax_full_mha__ssm_conv_h3__prompt_kernel
.p2align 8
.type concat_heads__softmax_full_mha__ssm_conv_h3__prompt_kernel,@function
concat_heads__softmax_full_mha__ssm_conv_h3__prompt_kernel:
    s_cmp_ge_u32 s2, 256
    s_cbranch_scc1 L_end
    s_load_dwordx16 s[64:79], s[0:1], 0
    s_memrealtime s[96:97]
    s_load_dwordx8 s[80:87], s[0:1], 64
    v_mov_b32 v252, v0
    v_lshrrev_b32 v140, 6, v0
    v_and_b32 v250, 63, v0
    s_and_b32 s37, s2, 7
    v_readfirstlane_b32 s24, v140
    s_lshr_b32 s38, s2, 3
    v_lshlrev_b32 v251, 4, v250
    s_cmp_ge_u32 s38, 24
    s_cbranch_scc1 L_ssmwg
    s_mul_i32 s39, s38, 43
    s_lshr_b32 s39, s39, 8
    s_mul_i32 s36, s39, 6
    s_sub_u32 s38, s38, s36
    s_lshr_b32 s35, s37, 1
    s_lshl_b32 s36, s39, 2
    s_add_u32 s35, s35, s36
    s_and_b32 s36, s37, 1
    s_add_u32 s36, s36, s38
    s_add_u32 s36, s36, s38
    s_cmp_lt_u32 s24, 4
    s_cbranch_scc1 L_cons
    s_add_u32 s43, s39, s38
    s_mul_i32 s43, s43, 3
    s_cmp_ge_u32 s43, 18
    s_cselect_b32 s46, 18, 0
    s_sub_u32 s43, s43, s46
    s_cmp_ge_u32 s43, 9
    s_cselect_b32 s37, 9, 0
    s_sub_u32 s43, s43, s37
    s_and_b32 s39, s24, 3
    v_lshrrev_b32 v140, 3, v250
    s_lshl_b32 s37, s35, 7
    s_lshl_b32 s38, s39, 5
    s_add_u32 s37, s37, s38
    v_add_u32 v140, s37, v140
    v_mul_u32_u24 v140, 1152, v140
    v_lshrrev_b32 v141, 4, v250
    v_and_b32 v142, 7, v250
    v_xor_b32 v142, v142, v141
    v_lshl_add_u32 v128, v142, 4, v140
    v_xor_b32 v142, 4, v142
    v_lshl_add_u32 v129, v142, 4, v140
    v_add_u32 v129, 9216, v129
    s_mul_i32 s37, s36, 288
    s_and_b32 s37, s37, 0xffffffc0
    s_mul_i32 s38, s39, 55296
    s_add_u32 s37, s37, s38
    v_add_u32 v140, 0, v250
    v_mul_u32_u24 v141, 205, v140
    v_lshrrev_b32 v141, 12, v141
    v_lshrrev_b32 v142, 2, v141
    v_and_b32 v142, 2, v142
    v_xor_b32 v140, v140, v142
    v_mul_u32_u24 v141, 3136, v141
    v_lshl_add_u32 v141, v140, 4, v141
    v_add_u32 v130, s37, v141
    v_add_u32 v140, 64, v250
    v_mul_u32_u24 v141, 205, v140
    v_lshrrev_b32 v141, 12, v141
    v_lshrrev_b32 v142, 2, v141
    v_and_b32 v142, 2, v142
    v_xor_b32 v140, v140, v142
    v_mul_u32_u24 v141, 3136, v141
    v_lshl_add_u32 v141, v140, 4, v141
    v_add_u32 v131, s37, v141
    v_add_u32 v140, 128, v250
    v_mul_u32_u24 v141, 205, v140
    v_lshrrev_b32 v141, 12, v141
    v_lshrrev_b32 v142, 2, v141
    v_and_b32 v142, 2, v142
    v_xor_b32 v140, v140, v142
    v_mul_u32_u24 v141, 3136, v141
    v_lshl_add_u32 v141, v140, 4, v141
    v_add_u32 v132, s37, v141
    v_add_u32 v140, 192, v250
    v_mul_u32_u24 v141, 205, v140
    v_lshrrev_b32 v141, 12, v141
    v_lshrrev_b32 v142, 2, v141
    v_and_b32 v142, 2, v142
    v_xor_b32 v140, v140, v142
    v_mul_u32_u24 v141, 3136, v141
    v_lshl_add_u32 v141, v140, 4, v141
    v_add_u32 v133, s37, v141
    v_add_u32 v140, 256, v250
    v_mul_u32_u24 v141, 205, v140
    v_lshrrev_b32 v141, 12, v141
    v_lshrrev_b32 v142, 2, v141
    v_and_b32 v142, 2, v142
    v_xor_b32 v140, v140, v142
    v_mul_u32_u24 v141, 3136, v141
    v_lshl_add_u32 v141, v140, 4, v141
    v_add_u32 v134, s37, v141
    s_lshl_b32 s42, s39, 12
    s_mul_i32 s46, s39, 5120
    s_add_u32 s46, s46, 16384
    s_mov_b32 s14, 2359296
    s_mov_b32 s15, 0x20000
    s_mov_b32 s18, 1990656
    s_mov_b32 s19, 0x20000
    s_mov_b32 s44, 0
    s_mov_b32 s47, 0
    s_waitcnt lgkmcnt(0)
    s_mov_b64 s[12:13], s[64:65]
    s_mov_b64 s[16:17], s[66:67]
L_prod:
    s_lshl_b32 s40, s43, 7
    s_mul_i32 s41, s43, 221184
    s_add_u32 s48, s42, s47
    s_add_u32 s49, s46, s47
    s_add_u32 m0, s49, 0
    s_nop 0
    buffer_load_dwordx4 v130, s[16:19], s41 offen lds
    s_add_u32 m0, s48, 0
    s_nop 0
    buffer_load_dwordx4 v128, s[12:15], s40 offen lds
    s_add_u32 m0, s49, 1024
    s_nop 0
    buffer_load_dwordx4 v131, s[16:19], s41 offen lds
    s_add_u32 m0, s48, 1024
    s_nop 0
    buffer_load_dwordx4 v129, s[12:15], s40 offen lds
    s_add_u32 m0, s49, 2048
    s_nop 0
    buffer_load_dwordx4 v132, s[16:19], s41 offen lds
    s_add_u32 m0, s48, 2048
    s_add_u32 s40, s40, 18432
    buffer_load_dwordx4 v128, s[12:15], s40 offen lds
    s_add_u32 m0, s49, 3072
    s_nop 0
    buffer_load_dwordx4 v133, s[16:19], s41 offen lds
    s_add_u32 m0, s48, 3072
    s_nop 0
    buffer_load_dwordx4 v129, s[12:15], s40 offen lds
    s_add_u32 m0, s49, 4096
    s_nop 0
    buffer_load_dwordx4 v134, s[16:19], s41 offen lds
    s_add_u32 s47, s47, 36864
    s_cmp_eq_u32 s47, 110592
    s_cselect_b32 s47, 0, s47
    s_add_u32 s43, s43, 1
    s_cmp_eq_u32 s43, 9
    s_cselect_b32 s43, 0, s43
    s_add_u32 s44, s44, 1
    s_cmp_lt_u32 s44, 2
    s_cbranch_scc1 L_prod
    s_waitcnt vmcnt(9)
    s_barrier
    s_cmp_lt_u32 s44, 9
    s_cbranch_scc1 L_prod
    s_mov_b64 s[8:9], s[86:87]
    s_mov_b32 s10, 14811136
    s_mov_b32 s11, 0x20000
    s_mov_b64 s[4:5], s[84:85]
    s_mov_b32 s6, 256
    s_mov_b32 s7, 0x20000
    s_and_b32 s31, s2, 7
    s_lshl_b32 s31, s31, 2
    s_bfe_u32 s26, s2, 0x20003
    s_add_u32 s31, s31, s26
    s_lshr_b32 s32, s2, 5
    s_lshl_b32 s32, s32, 3
    s_and_b32 s26, s24, 3
    s_lshl_b32 s26, s26, 1
    s_add_u32 s32, s32, s26
    s_lshr_b32 s26, s24, 2
    s_add_u32 s32, s32, s26
    s_mul_i32 s51, s31, 155648
    s_add_u32 s51, s51, 2359296
    s_lshr_b32 s26, s2, 6
    s_mul_i32 s26, s26, 144
    s_and_b32 s27, s2, 63
    s_lshl_b32 s59, s27, 1
    s_add_u32 s59, s59, s26
    s_lshr_b32 s26, s27, 4
    s_mul_i32 s26, s26, 144
    s_and_b32 s60, s27, 15
    s_add_u32 s60, s60, s26
    s_add_u32 s60, s60, 128
    s_mov_b64 s[20:21], s[78:79]
    s_mov_b32 s22, 2359296
    s_mov_b32 s23, 0x20000
    s_and_b32 s26, s24, 3
    s_lshl_b32 s26, s26, 10
    s_lshl_b32 s27, s59, 12
    s_lshl_b32 s29, s60, 12
    v_mov_b32 v141, s29
    v_lshlrev_b32 v140, 11, v250
    v_and_b32 v140, 4096, v140
    v_cmp_gt_u32 vcc, 4, v250
    v_add_u32 v140, s27, v140
    s_add_u32 s27, s27, s26
    s_add_u32 s28, s27, 4096
    s_add_u32 s29, s29, s26
    v_cndmask_b32 v140, v141, v140, vcc
    v_mov_b32 v253, 0
    s_add_u32 m0, s26, 134752
    s_nop 0
    buffer_load_dwordx4 v251, s[20:23], s27 offen lds
    s_add_u32 m0, s26, 143072
    s_nop 0
    buffer_load_dwordx4 v251, s[20:23], s28 offen lds
    s_add_u32 m0, s26, 130592
    s_add_u32 s27, s27, 2
    buffer_load_dwordx4 v251, s[20:23], s27 offen lds
    s_add_u32 m0, s26, 138912
    s_add_u32 s28, s28, 2
    buffer_load_dwordx4 v251, s[20:23], s28 offen lds
    buffer_load_dword v249, v140, s[20:23], 0 offen
    buffer_load_dword v253, v253, s[4:7], 0 offen sc1
    s_mov_b32 s63, 0
    s_mov_b32 s27, 14450688
    v_lshlrev_b32 v142, 7, v250
    buffer_load_dword v143, v142, s[8:11], s27 offen sc1
    s_waitcnt vmcnt(7)
    s_barrier
    s_waitcnt vmcnt(0)
    s_cmp_lg_u32 s24, 7
    s_cbranch_scc1 L_hfa
    v_mul_u32_u24 v136, 4160, v250
    v_and_b32 v137, 1, v250
    v_cmp_eq_u32 vcc, 0, v137
    v_mov_b64 v[240:241], 0
    v_mov_b64 v[242:243], 0
    v_mov_b64 v[244:245], 0
    v_mov_b32 v246, 0
    v_lshlrev_b32 v137, 16, v249
    v_cndmask_b32 v247, 0, v137, vcc
    v_add_u32 v136, 130560, v136
    s_mov_b64 exec, 63
    ds_write_b128 v136, v[240:243]
    ds_write_b128 v136, v[244:247] offset:16
    s_mov_b64 exec, -1
L_hfa:
    v_mov_b32 v138, 163792
    v_mov_b32 v139, 1
    s_mov_b64 exec, 1
    ds_add_u32 v138, v139
    s_mov_b64 exec, -1
    v_readfirstlane_b32 s25, v253
    s_sub_u32 s29, s96, s25
    s_cmp_gt_u32 s29, 1000
    s_cselect_b32 s28, 1, 0
    s_sub_u32 s29, s25, s96
    s_cmp_gt_u32 s29, 1000
    s_cselect_b32 s28, s28, 0
    s_cmp_lg_u32 s28, 0
    s_cbranch_scc1 L_epi2
    s_cmp_eq_u32 s25, 0
    s_cbranch_scc1 L_epi2
    v_cmp_ne_u32 vcc, s25, v143
    s_cmp_eq_u64 vcc, 0
    s_cbranch_scc0 L_epi2
    v_lshrrev_b32 v140, 2, v250
    v_sub_u32 v140, 15, v140
    v_mul_u32_u24 v140, 36864, v140
    v_and_b32 v141, 48, v251
    v_add_u32 v140, v140, v141
    s_and_b32 s26, s24, 3
    s_mul_i32 s28, s26, 589824
    s_sub_u32 s28, 11468800, s28
    s_lshl_b32 s26, s26, 10
    s_lshl_b32 s29, s59, 6
    s_add_u32 s29, s29, s28
    s_add_u32 m0, s26, 116736
    s_nop 0
    buffer_load_dwordx4 v140, s[8:11], s29 offen sc1 lds
    s_add_u32 m0, s26, 121344
    s_add_u32 s29, s29, 64
    buffer_load_dwordx4 v140, s[8:11], s29 offen sc1 lds
    s_mov_b32 s63, 1
    v_mov_b32 v142, 163836
    v_mov_b32 v143, 1
    s_mov_b64 exec, 1
    ds_add_u32 v142, v143
    s_mov_b64 exec, -1
    s_branch L_epi2
L_cons:
    s_and_b32 s33, s24, 1
    s_lshr_b32 s34, s24, 1
    v_and_b32 v140, 15, v250
    v_lshrrev_b32 v141, 4, v250
    v_lshrrev_b32 v142, 1, v140
    v_xor_b32 v142, v142, v141
    v_lshlrev_b32 v142, 4, v142
    v_lshl_add_u32 v142, v140, 7, v142
    s_lshl_b32 s37, s33, 13
    s_lshl_b32 s38, s34, 12
    s_add_u32 s37, s37, s38
    v_add_u32 v160, s37, v142
    v_xor_b32 v161, 4096, v160
    v_xor_b32 v162, 64, v160
    v_xor_b32 v163, 64, v161
    v_bfe_u32 v142, v250, 2, 2
    v_lshl_add_u32 v143, v141, 3, v142
    v_mul_u32_u24 v143, 320, v143
    v_add_u32 v143, 16384, v143
    s_and_b32 s37, s36, 1
    s_lshl_b32 s37, s37, 5
    s_mul_i32 s38, s34, 144
    s_add_u32 s38, s38, s37
    v_and_b32 v140, 3, v250
    v_and_b32 v141, 16, v250
    v_lshlrev_b32 v141, 1, v141
    v_lshl_add_u32 v142, v140, 3, s38
    v_add_u32 v168, 0, v142
    v_xor_b32 v168, v168, v141
    v_add_u32 v168, v168, v143
    v_add_u32 v169, 40, v142
    v_xor_b32 v169, v169, v141
    v_add_u32 v169, v169, v143
    v_add_u32 v170, 72, v142
    v_xor_b32 v170, v170, v141
    v_add_u32 v170, v170, v143
    v_add_u32 v171, 112, v142
    v_xor_b32 v171, v171, v141
    v_add_u32 v171, v171, v143
    v_mul_u32_u24 v140, 72, v140
    v_add3_u32 v140, v140, 32, s37
    v_xor_b32 v140, v140, v141
    v_add_u32 v172, v140, v143
    s_mov_b32 s37, 73728
    v_add_u32 v164, s37, v160
    v_add_u32 v165, s37, v161
    v_add_u32 v166, s37, v162
    v_add_u32 v167, s37, v163
    v_add_u32 v173, s37, v168
    v_add_u32 v174, s37, v169
    v_add_u32 v175, s37, v170
    v_add_u32 v176, s37, v171
    v_add_u32 v177, s37, v172
    v_mov_b64 v[0:1], 0
    v_mov_b64 v[2:3], 0
    v_mov_b64 v[4:5], 0
    v_mov_b64 v[6:7], 0
    v_mov_b64 v[8:9], 0
    v_mov_b64 v[10:11], 0
    v_mov_b64 v[12:13], 0
    v_mov_b64 v[14:15], 0
    v_mov_b64 v[16:17], 0
    v_mov_b64 v[18:19], 0
    v_mov_b64 v[20:21], 0
    v_mov_b64 v[22:23], 0
    v_mov_b64 v[24:25], 0
    v_mov_b64 v[26:27], 0
    v_mov_b64 v[28:29], 0
    v_mov_b64 v[30:31], 0
    v_mov_b64 v[32:33], 0
    v_mov_b64 v[34:35], 0
    v_mov_b64 v[36:37], 0
    v_mov_b64 v[38:39], 0
    v_mov_b64 v[40:41], 0
    v_mov_b64 v[42:43], 0
    v_mov_b64 v[44:45], 0
    v_mov_b64 v[46:47], 0
    v_mov_b64 v[48:49], 0
    v_mov_b64 v[50:51], 0
    v_mov_b64 v[52:53], 0
    v_mov_b64 v[54:55], 0
    v_mov_b64 v[56:57], 0
    v_mov_b64 v[58:59], 0
    v_mov_b64 v[60:61], 0
    v_mov_b64 v[62:63], 0
    v_mov_b64 v[64:65], 0
    v_mov_b64 v[66:67], 0
    v_mov_b64 v[68:69], 0
    v_mov_b64 v[70:71], 0
    s_waitcnt lgkmcnt(0)
    s_mov_b64 s[8:9], s[86:87]
    s_mov_b32 s10, 14811136
    s_mov_b32 s11, 0x20000
    s_mov_b64 s[4:5], s[84:85]
    s_mov_b32 s6, 256
    s_mov_b32 s7, 0x20000
    s_and_b32 s31, s2, 7
    s_lshl_b32 s31, s31, 2
    s_bfe_u32 s26, s2, 0x20003
    s_add_u32 s31, s31, s26
    s_lshr_b32 s32, s2, 5
    s_lshl_b32 s32, s32, 3
    s_and_b32 s26, s24, 3
    s_lshl_b32 s26, s26, 1
    s_add_u32 s32, s32, s26
    s_lshr_b32 s26, s24, 2
    s_add_u32 s32, s32, s26
    s_mul_i32 s51, s31, 155648
    s_add_u32 s51, s51, 2359296
    s_lshr_b32 s26, s2, 6
    s_mul_i32 s26, s26, 144
    s_and_b32 s27, s2, 63
    s_lshl_b32 s59, s27, 1
    s_add_u32 s59, s59, s26
    s_lshr_b32 s26, s27, 4
    s_mul_i32 s26, s26, 144
    s_and_b32 s60, s27, 15
    s_add_u32 s60, s60, s26
    s_add_u32 s60, s60, 128
    s_lshl_b32 s26, s59, 1
    s_load_dword s52, s[80:81], s26
    s_lshr_b32 s26, s60, 1
    s_lshl_b32 s26, s26, 2
    s_load_dword s53, s[80:81], s26
    v_mov_b64 v[244:245], 0
    v_mov_b64 v[246:247], 0
    v_and_b32 v248, 496, v251
    v_add_u32 v248, 120832, v248
    ds_write_b128 v248, v[244:247]
    ds_write_b128 v248, v[244:247] offset:4608
    ds_write_b128 v248, v[244:247] offset:9216
    v_and_b32 v248, 48, v251
    v_add_u32 v248, 163776, v248
    ds_write_b128 v248, v[244:247]
    s_or_b32 s37, s2, s24
    s_cmp_lg_u32 s37, 0
    s_cbranch_scc1 L_nononce
    s_or_b32 s46, s96, 1
    v_mov_b32 v140, s46
    s_mov_b64 exec, 1
    buffer_store_dword v140, v251, s[4:7], 0 offen sc1
    s_mov_b64 exec, -1
L_nononce:
    s_mov_b32 s44, 0
    s_and_b32 s48, s36, 3
    s_lshl_b32 s48, s48, 2
    s_add_u32 s48, s48, s24
    s_lshl_b32 s48, s48, 5
    s_add_u32 s48, s48, s35
    s_mul_i32 s54, s48, 4608
    s_mul_i32 s38, s48, 9728
    s_add_u32 s38, s38, 2359296
    s_mov_b32 s55, 155648
    s_cmp_lt_u32 s36, 4
    s_cselect_b32 s54, s54, s38
    s_cselect_b32 s55, 73728, s55
    s_cmp_ge_u32 s36, 8
    s_cselect_b32 s38, 4608, 0
    s_cselect_b32 s56, 4096, s38
    s_add_u32 s54, s54, s38
    s_cmp_lt_u32 s36, 8
    s_cselect_b32 s56, 3584, s56
    s_add_u32 s55, s55, s54
    s_add_u32 s57, s55, s56
    s_add_u32 s56, s54, s56
    s_waitcnt lgkmcnt(0)
    s_barrier
    ds_read_b128 v[72:75], v160 offset:0
    ds_read_b128 v[76:79], v160 offset:2048
    ds_read_b128 v[80:83], v161 offset:0
    ds_read_b128 v[84:87], v161 offset:2048
    ds_read_b64_tr_b16 v[104:105], v168 offset:0
    ds_read_b64_tr_b16 v[106:107], v168 offset:1280
    ds_read_b64_tr_b16 v[108:109], v169 offset:0
    ds_read_b64_tr_b16 v[110:111], v169 offset:1280
    ds_read_b64_tr_b16 v[112:113], v170 offset:0
    ds_read_b64_tr_b16 v[114:115], v170 offset:1280
    ds_read_b64_tr_b16 v[116:117], v171 offset:0
    ds_read_b64_tr_b16 v[118:119], v171 offset:1280
    ds_read_b64_tr_b16 v[120:121], v172 offset:0
    ds_read_b64_tr_b16 v[122:123], v172 offset:1280
L_gemm:
    s_waitcnt lgkmcnt(8)
    v_mfma_f32_16x16x32_bf16 v[0:3], v[104:107], v[72:75], v[0:3]
    ds_read_b128 v[88:91], v162 offset:0
    ds_read_b128 v[92:95], v162 offset:2048
    v_mfma_f32_16x16x32_bf16 v[4:7], v[104:107], v[76:79], v[4:7]
    ds_read_b128 v[96:99], v163 offset:0
    ds_read_b128 v[100:103], v163 offset:2048
    v_mfma_f32_16x16x32_bf16 v[8:11], v[104:107], v[80:83], v[8:11]
    v_mfma_f32_16x16x32_bf16 v[12:15], v[104:107], v[84:87], v[12:15]
    ds_read_b64_tr_b16 v[104:105], v168 offset:10240
    ds_read_b64_tr_b16 v[106:107], v168 offset:11520
    s_waitcnt lgkmcnt(12)
    v_mfma_f32_16x16x32_bf16 v[16:19], v[108:111], v[72:75], v[16:19]
    v_mfma_f32_16x16x32_bf16 v[20:23], v[108:111], v[76:79], v[20:23]
    v_mfma_f32_16x16x32_bf16 v[24:27], v[108:111], v[80:83], v[24:27]
    v_mfma_f32_16x16x32_bf16 v[28:31], v[108:111], v[84:87], v[28:31]
    ds_read_b64_tr_b16 v[108:109], v169 offset:10240
    ds_read_b64_tr_b16 v[110:111], v169 offset:11520
    s_waitcnt lgkmcnt(12)
    v_mfma_f32_16x16x32_bf16 v[32:35], v[112:115], v[72:75], v[32:35]
    v_mfma_f32_16x16x32_bf16 v[36:39], v[112:115], v[76:79], v[36:39]
    v_mfma_f32_16x16x32_bf16 v[40:43], v[112:115], v[80:83], v[40:43]
    v_mfma_f32_16x16x32_bf16 v[44:47], v[112:115], v[84:87], v[44:47]
    ds_read_b64_tr_b16 v[112:113], v170 offset:10240
    ds_read_b64_tr_b16 v[114:115], v170 offset:11520
    s_waitcnt lgkmcnt(12)
    v_mfma_f32_16x16x32_bf16 v[48:51], v[116:119], v[72:75], v[48:51]
    v_mfma_f32_16x16x32_bf16 v[52:55], v[116:119], v[76:79], v[52:55]
    v_mfma_f32_16x16x32_bf16 v[56:59], v[116:119], v[80:83], v[56:59]
    v_mfma_f32_16x16x32_bf16 v[60:63], v[116:119], v[84:87], v[60:63]
    ds_read_b64_tr_b16 v[116:117], v171 offset:10240
    ds_read_b64_tr_b16 v[118:119], v171 offset:11520
    s_waitcnt lgkmcnt(12)
    v_mfma_f32_16x16x32_bf16 v[64:67], v[120:123], v[72:75], v[64:67]
    v_mfma_f32_16x16x32_bf16 v[68:71], v[120:123], v[76:79], v[68:71]
    ds_read_b64_tr_b16 v[120:121], v172 offset:10240
    ds_read_b64_tr_b16 v[122:123], v172 offset:11520
    s_waitcnt lgkmcnt(8)
    v_mfma_f32_16x16x32_bf16 v[0:3], v[104:107], v[88:91], v[0:3]
    v_mfma_f32_16x16x32_bf16 v[4:7], v[104:107], v[92:95], v[4:7]
    v_mfma_f32_16x16x32_bf16 v[8:11], v[104:107], v[96:99], v[8:11]
    v_mfma_f32_16x16x32_bf16 v[12:15], v[104:107], v[100:103], v[12:15]
    s_waitcnt lgkmcnt(0)
    s_barrier
    v_mfma_f32_16x16x32_bf16 v[16:19], v[108:111], v[88:91], v[16:19]
    ds_read_b128 v[72:75], v160 offset:36864
    ds_read_b128 v[76:79], v160 offset:38912
    v_mfma_f32_16x16x32_bf16 v[20:23], v[108:111], v[92:95], v[20:23]
    ds_read_b128 v[80:83], v161 offset:36864
    ds_read_b128 v[84:87], v161 offset:38912
    v_mfma_f32_16x16x32_bf16 v[24:27], v[108:111], v[96:99], v[24:27]
    ds_read_b64_tr_b16 v[104:105], v168 offset:36864
    ds_read_b64_tr_b16 v[106:107], v168 offset:38144
    v_mfma_f32_16x16x32_bf16 v[28:31], v[108:111], v[100:103], v[28:31]
    ds_read_b64_tr_b16 v[108:109], v169 offset:36864
    ds_read_b64_tr_b16 v[110:111], v169 offset:38144
    v_mfma_f32_16x16x32_bf16 v[32:35], v[112:115], v[88:91], v[32:35]
    v_mfma_f32_16x16x32_bf16 v[36:39], v[112:115], v[92:95], v[36:39]
    v_mfma_f32_16x16x32_bf16 v[40:43], v[112:115], v[96:99], v[40:43]
    v_mfma_f32_16x16x32_bf16 v[44:47], v[112:115], v[100:103], v[44:47]
    ds_read_b64_tr_b16 v[112:113], v170 offset:36864
    ds_read_b64_tr_b16 v[114:115], v170 offset:38144
    v_mfma_f32_16x16x32_bf16 v[48:51], v[116:119], v[88:91], v[48:51]
    v_mfma_f32_16x16x32_bf16 v[52:55], v[116:119], v[92:95], v[52:55]
    v_mfma_f32_16x16x32_bf16 v[56:59], v[116:119], v[96:99], v[56:59]
    v_mfma_f32_16x16x32_bf16 v[60:63], v[116:119], v[100:103], v[60:63]
    ds_read_b64_tr_b16 v[116:117], v171 offset:36864
    ds_read_b64_tr_b16 v[118:119], v171 offset:38144
    v_mfma_f32_16x16x32_bf16 v[64:67], v[120:123], v[88:91], v[64:67]
    v_mfma_f32_16x16x32_bf16 v[68:71], v[120:123], v[92:95], v[68:71]
    ds_read_b64_tr_b16 v[120:121], v172 offset:36864
    ds_read_b64_tr_b16 v[122:123], v172 offset:38144
    s_waitcnt lgkmcnt(8)
    v_mfma_f32_16x16x32_bf16 v[0:3], v[104:107], v[72:75], v[0:3]
    ds_read_b128 v[88:91], v162 offset:36864
    ds_read_b128 v[92:95], v162 offset:38912
    v_mfma_f32_16x16x32_bf16 v[4:7], v[104:107], v[76:79], v[4:7]
    ds_read_b128 v[96:99], v163 offset:36864
    ds_read_b128 v[100:103], v163 offset:38912
    v_mfma_f32_16x16x32_bf16 v[8:11], v[104:107], v[80:83], v[8:11]
    v_mfma_f32_16x16x32_bf16 v[12:15], v[104:107], v[84:87], v[12:15]
    ds_read_b64_tr_b16 v[104:105], v168 offset:47104
    ds_read_b64_tr_b16 v[106:107], v168 offset:48384
    s_waitcnt lgkmcnt(12)
    v_mfma_f32_16x16x32_bf16 v[16:19], v[108:111], v[72:75], v[16:19]
    v_mfma_f32_16x16x32_bf16 v[20:23], v[108:111], v[76:79], v[20:23]
    v_mfma_f32_16x16x32_bf16 v[24:27], v[108:111], v[80:83], v[24:27]
    v_mfma_f32_16x16x32_bf16 v[28:31], v[108:111], v[84:87], v[28:31]
    ds_read_b64_tr_b16 v[108:109], v169 offset:47104
    ds_read_b64_tr_b16 v[110:111], v169 offset:48384
    s_waitcnt lgkmcnt(12)
    v_mfma_f32_16x16x32_bf16 v[32:35], v[112:115], v[72:75], v[32:35]
    v_mfma_f32_16x16x32_bf16 v[36:39], v[112:115], v[76:79], v[36:39]
    v_mfma_f32_16x16x32_bf16 v[40:43], v[112:115], v[80:83], v[40:43]
    v_mfma_f32_16x16x32_bf16 v[44:47], v[112:115], v[84:87], v[44:47]
    ds_read_b64_tr_b16 v[112:113], v170 offset:47104
    ds_read_b64_tr_b16 v[114:115], v170 offset:48384
    s_waitcnt lgkmcnt(12)
    v_mfma_f32_16x16x32_bf16 v[48:51], v[116:119], v[72:75], v[48:51]
    v_mfma_f32_16x16x32_bf16 v[52:55], v[116:119], v[76:79], v[52:55]
    v_mfma_f32_16x16x32_bf16 v[56:59], v[116:119], v[80:83], v[56:59]
    v_mfma_f32_16x16x32_bf16 v[60:63], v[116:119], v[84:87], v[60:63]
    ds_read_b64_tr_b16 v[116:117], v171 offset:47104
    ds_read_b64_tr_b16 v[118:119], v171 offset:48384
    s_waitcnt lgkmcnt(12)
    v_mfma_f32_16x16x32_bf16 v[64:67], v[120:123], v[72:75], v[64:67]
    v_mfma_f32_16x16x32_bf16 v[68:71], v[120:123], v[76:79], v[68:71]
    ds_read_b64_tr_b16 v[120:121], v172 offset:47104
    ds_read_b64_tr_b16 v[122:123], v172 offset:48384
    s_waitcnt lgkmcnt(8)
    v_mfma_f32_16x16x32_bf16 v[0:3], v[104:107], v[88:91], v[0:3]
    v_mfma_f32_16x16x32_bf16 v[4:7], v[104:107], v[92:95], v[4:7]
    v_mfma_f32_16x16x32_bf16 v[8:11], v[104:107], v[96:99], v[8:11]
    v_mfma_f32_16x16x32_bf16 v[12:15], v[104:107], v[100:103], v[12:15]
    s_waitcnt lgkmcnt(0)
    s_barrier
    v_mfma_f32_16x16x32_bf16 v[16:19], v[108:111], v[88:91], v[16:19]
    ds_read_b128 v[72:75], v164 offset:0
    ds_read_b128 v[76:79], v164 offset:2048
    v_mfma_f32_16x16x32_bf16 v[20:23], v[108:111], v[92:95], v[20:23]
    ds_read_b128 v[80:83], v165 offset:0
    ds_read_b128 v[84:87], v165 offset:2048
    v_mfma_f32_16x16x32_bf16 v[24:27], v[108:111], v[96:99], v[24:27]
    ds_read_b64_tr_b16 v[104:105], v173 offset:0
    ds_read_b64_tr_b16 v[106:107], v173 offset:1280
    v_mfma_f32_16x16x32_bf16 v[28:31], v[108:111], v[100:103], v[28:31]
    ds_read_b64_tr_b16 v[108:109], v174 offset:0
    ds_read_b64_tr_b16 v[110:111], v174 offset:1280
    v_mfma_f32_16x16x32_bf16 v[32:35], v[112:115], v[88:91], v[32:35]
    v_mfma_f32_16x16x32_bf16 v[36:39], v[112:115], v[92:95], v[36:39]
    v_mfma_f32_16x16x32_bf16 v[40:43], v[112:115], v[96:99], v[40:43]
    v_mfma_f32_16x16x32_bf16 v[44:47], v[112:115], v[100:103], v[44:47]
    ds_read_b64_tr_b16 v[112:113], v175 offset:0
    ds_read_b64_tr_b16 v[114:115], v175 offset:1280
    v_mfma_f32_16x16x32_bf16 v[48:51], v[116:119], v[88:91], v[48:51]
    v_mfma_f32_16x16x32_bf16 v[52:55], v[116:119], v[92:95], v[52:55]
    v_mfma_f32_16x16x32_bf16 v[56:59], v[116:119], v[96:99], v[56:59]
    v_mfma_f32_16x16x32_bf16 v[60:63], v[116:119], v[100:103], v[60:63]
    ds_read_b64_tr_b16 v[116:117], v176 offset:0
    ds_read_b64_tr_b16 v[118:119], v176 offset:1280
    v_mfma_f32_16x16x32_bf16 v[64:67], v[120:123], v[88:91], v[64:67]
    v_mfma_f32_16x16x32_bf16 v[68:71], v[120:123], v[92:95], v[68:71]
    ds_read_b64_tr_b16 v[120:121], v177 offset:0
    ds_read_b64_tr_b16 v[122:123], v177 offset:1280
    s_waitcnt lgkmcnt(8)
    v_mfma_f32_16x16x32_bf16 v[0:3], v[104:107], v[72:75], v[0:3]
    ds_read_b128 v[88:91], v166 offset:0
    ds_read_b128 v[92:95], v166 offset:2048
    v_mfma_f32_16x16x32_bf16 v[4:7], v[104:107], v[76:79], v[4:7]
    ds_read_b128 v[96:99], v167 offset:0
    ds_read_b128 v[100:103], v167 offset:2048
    v_mfma_f32_16x16x32_bf16 v[8:11], v[104:107], v[80:83], v[8:11]
    v_mfma_f32_16x16x32_bf16 v[12:15], v[104:107], v[84:87], v[12:15]
    ds_read_b64_tr_b16 v[104:105], v173 offset:10240
    ds_read_b64_tr_b16 v[106:107], v173 offset:11520
    s_waitcnt lgkmcnt(12)
    v_mfma_f32_16x16x32_bf16 v[16:19], v[108:111], v[72:75], v[16:19]
    v_mfma_f32_16x16x32_bf16 v[20:23], v[108:111], v[76:79], v[20:23]
    v_mfma_f32_16x16x32_bf16 v[24:27], v[108:111], v[80:83], v[24:27]
    v_mfma_f32_16x16x32_bf16 v[28:31], v[108:111], v[84:87], v[28:31]
    ds_read_b64_tr_b16 v[108:109], v174 offset:10240
    ds_read_b64_tr_b16 v[110:111], v174 offset:11520
    s_waitcnt lgkmcnt(12)
    v_mfma_f32_16x16x32_bf16 v[32:35], v[112:115], v[72:75], v[32:35]
    v_mfma_f32_16x16x32_bf16 v[36:39], v[112:115], v[76:79], v[36:39]
    v_mfma_f32_16x16x32_bf16 v[40:43], v[112:115], v[80:83], v[40:43]
    v_mfma_f32_16x16x32_bf16 v[44:47], v[112:115], v[84:87], v[44:47]
    ds_read_b64_tr_b16 v[112:113], v175 offset:10240
    ds_read_b64_tr_b16 v[114:115], v175 offset:11520
    s_waitcnt lgkmcnt(12)
    v_mfma_f32_16x16x32_bf16 v[48:51], v[116:119], v[72:75], v[48:51]
    v_mfma_f32_16x16x32_bf16 v[52:55], v[116:119], v[76:79], v[52:55]
    v_mfma_f32_16x16x32_bf16 v[56:59], v[116:119], v[80:83], v[56:59]
    v_mfma_f32_16x16x32_bf16 v[60:63], v[116:119], v[84:87], v[60:63]
    ds_read_b64_tr_b16 v[116:117], v176 offset:10240
    ds_read_b64_tr_b16 v[118:119], v176 offset:11520
    s_waitcnt lgkmcnt(12)
    v_mfma_f32_16x16x32_bf16 v[64:67], v[120:123], v[72:75], v[64:67]
    v_mfma_f32_16x16x32_bf16 v[68:71], v[120:123], v[76:79], v[68:71]
    ds_read_b64_tr_b16 v[120:121], v177 offset:10240
    ds_read_b64_tr_b16 v[122:123], v177 offset:11520
    s_add_u32 s44, s44, 1
    s_cmp_eq_u32 s44, 3
    s_cbranch_scc1 L_gemm_last
    s_waitcnt lgkmcnt(8)
    v_mfma_f32_16x16x32_bf16 v[0:3], v[104:107], v[88:91], v[0:3]
    v_mfma_f32_16x16x32_bf16 v[4:7], v[104:107], v[92:95], v[4:7]
    v_mfma_f32_16x16x32_bf16 v[8:11], v[104:107], v[96:99], v[8:11]
    v_mfma_f32_16x16x32_bf16 v[12:15], v[104:107], v[100:103], v[12:15]
    s_waitcnt lgkmcnt(0)
    s_barrier
    v_mfma_f32_16x16x32_bf16 v[16:19], v[108:111], v[88:91], v[16:19]
    ds_read_b128 v[72:75], v160 offset:0
    ds_read_b128 v[76:79], v160 offset:2048
    v_mfma_f32_16x16x32_bf16 v[20:23], v[108:111], v[92:95], v[20:23]
    ds_read_b128 v[80:83], v161 offset:0
    ds_read_b128 v[84:87], v161 offset:2048
    v_mfma_f32_16x16x32_bf16 v[24:27], v[108:111], v[96:99], v[24:27]
    ds_read_b64_tr_b16 v[104:105], v168 offset:0
    ds_read_b64_tr_b16 v[106:107], v168 offset:1280
    v_mfma_f32_16x16x32_bf16 v[28:31], v[108:111], v[100:103], v[28:31]
    ds_read_b64_tr_b16 v[108:109], v169 offset:0
    ds_read_b64_tr_b16 v[110:111], v169 offset:1280
    v_mfma_f32_16x16x32_bf16 v[32:35], v[112:115], v[88:91], v[32:35]
    v_mfma_f32_16x16x32_bf16 v[36:39], v[112:115], v[92:95], v[36:39]
    v_mfma_f32_16x16x32_bf16 v[40:43], v[112:115], v[96:99], v[40:43]
    v_mfma_f32_16x16x32_bf16 v[44:47], v[112:115], v[100:103], v[44:47]
    ds_read_b64_tr_b16 v[112:113], v170 offset:0
    ds_read_b64_tr_b16 v[114:115], v170 offset:1280
    v_mfma_f32_16x16x32_bf16 v[48:51], v[116:119], v[88:91], v[48:51]
    v_mfma_f32_16x16x32_bf16 v[52:55], v[116:119], v[92:95], v[52:55]
    v_mfma_f32_16x16x32_bf16 v[56:59], v[116:119], v[96:99], v[56:59]
    v_mfma_f32_16x16x32_bf16 v[60:63], v[116:119], v[100:103], v[60:63]
    ds_read_b64_tr_b16 v[116:117], v171 offset:0
    ds_read_b64_tr_b16 v[118:119], v171 offset:1280
    v_mfma_f32_16x16x32_bf16 v[64:67], v[120:123], v[88:91], v[64:67]
    v_mfma_f32_16x16x32_bf16 v[68:71], v[120:123], v[92:95], v[68:71]
    ds_read_b64_tr_b16 v[120:121], v172 offset:0
    ds_read_b64_tr_b16 v[122:123], v172 offset:1280
    s_branch L_gemm
L_gemm_last:
    s_waitcnt lgkmcnt(8)
    v_mfma_f32_16x16x32_bf16 v[0:3], v[104:107], v[88:91], v[0:3]
    v_mfma_f32_16x16x32_bf16 v[4:7], v[104:107], v[92:95], v[4:7]
    v_mfma_f32_16x16x32_bf16 v[8:11], v[104:107], v[96:99], v[8:11]
    v_mfma_f32_16x16x32_bf16 v[12:15], v[104:107], v[100:103], v[12:15]
    s_waitcnt lgkmcnt(6)
    v_mfma_f32_16x16x32_bf16 v[16:19], v[108:111], v[88:91], v[16:19]
    v_mfma_f32_16x16x32_bf16 v[20:23], v[108:111], v[92:95], v[20:23]
    v_mfma_f32_16x16x32_bf16 v[24:27], v[108:111], v[96:99], v[24:27]
    v_mfma_f32_16x16x32_bf16 v[28:31], v[108:111], v[100:103], v[28:31]
    s_waitcnt lgkmcnt(4)
    v_mfma_f32_16x16x32_bf16 v[32:35], v[112:115], v[88:91], v[32:35]
    v_mfma_f32_16x16x32_bf16 v[36:39], v[112:115], v[92:95], v[36:39]
    v_mfma_f32_16x16x32_bf16 v[40:43], v[112:115], v[96:99], v[40:43]
    v_mfma_f32_16x16x32_bf16 v[44:47], v[112:115], v[100:103], v[44:47]
    s_waitcnt lgkmcnt(2)
    v_mfma_f32_16x16x32_bf16 v[48:51], v[116:119], v[88:91], v[48:51]
    v_mfma_f32_16x16x32_bf16 v[52:55], v[116:119], v[92:95], v[52:55]
    v_mfma_f32_16x16x32_bf16 v[56:59], v[116:119], v[96:99], v[56:59]
    v_mfma_f32_16x16x32_bf16 v[60:63], v[116:119], v[100:103], v[60:63]
    s_waitcnt lgkmcnt(0)
    v_mfma_f32_16x16x32_bf16 v[64:67], v[120:123], v[88:91], v[64:67]
    v_mfma_f32_16x16x32_bf16 v[68:71], v[120:123], v[92:95], v[68:71]
    v_mov_b32 v253, 0
    s_nop 0
    buffer_load_dword v253, v253, s[4:7], 0 offen sc1
    v_and_b32 v143, 15, v250
    v_lshrrev_b32 v142, 4, v250
    v_bfe_u32 v164, v250, 4, 1
    v_lshrrev_b32 v165, 5, v250
    s_mov_b32 s46, 0x3eae1a93
    s_mov_b32 s47, s46
    s_lshl_b32 s33, s33, 1
    s_add_u32 s33, s33, s34
    s_xor_b32 s49, s33, 1
    s_mul_i32 s34, s34, 20480
    s_cmp_ge_u32 s36, 8
    s_cbranch_scc1 L_epv
    v_lshlrev_b32 v140, 4, v143
    v_lshl_add_u32 v140, v164, 9, v140
    s_lshl_b32 s37, s33, 7
    s_add_u32 s37, s37, 4096
    v_lshl_add_u32 v141, v143, 2, s37
    s_movk_i32 s48, 256
    s_lshl_b32 s33, s33, 10
    s_lshl_b32 s49, s49, 10
    s_branch L_epc
L_epv:
    s_mul_i32 s33, s33, 1280
    s_mul_i32 s49, s49, 1280
    v_mul_u32_u24 v141, 40, v143
    v_lshl_add_u32 v140, v164, 4, v141
    v_add3_u32 v141, v141, 32, s33
    s_movk_i32 s48, 640
L_epc:
    v_lshl_add_u32 v140, v165, 3, v140
    v_mul_u32_u24 v142, 10240, v142
    v_add_u32 v141, v141, v142
    s_add_u32 s33, s33, s34
    s_add_u32 s49, s49, s34
    v_add_u32 v160, s33, v140
    v_add_u32 v162, s49, v140
    v_add_u32 v161, s48, v160
    v_add_u32 v163, s48, v162
    s_cmp_ge_u32 s36, 4
    s_cbranch_scc1 L_nosc
    v_pk_mul_f32 v[0:1], v[0:1], s[46:47]
    v_pk_mul_f32 v[2:3], v[2:3], s[46:47]
    v_pk_mul_f32 v[4:5], v[4:5], s[46:47]
    v_pk_mul_f32 v[6:7], v[6:7], s[46:47]
    v_pk_mul_f32 v[8:9], v[8:9], s[46:47]
    v_pk_mul_f32 v[10:11], v[10:11], s[46:47]
    v_pk_mul_f32 v[12:13], v[12:13], s[46:47]
    v_pk_mul_f32 v[14:15], v[14:15], s[46:47]
    v_pk_mul_f32 v[16:17], v[16:17], s[46:47]
    v_pk_mul_f32 v[18:19], v[18:19], s[46:47]
    v_pk_mul_f32 v[20:21], v[20:21], s[46:47]
    v_pk_mul_f32 v[22:23], v[22:23], s[46:47]
    v_pk_mul_f32 v[24:25], v[24:25], s[46:47]
    v_pk_mul_f32 v[26:27], v[26:27], s[46:47]
    v_pk_mul_f32 v[28:29], v[28:29], s[46:47]
    v_pk_mul_f32 v[30:31], v[30:31], s[46:47]
    v_pk_mul_f32 v[32:33], v[32:33], s[46:47]
    v_pk_mul_f32 v[34:35], v[34:35], s[46:47]
    v_pk_mul_f32 v[36:37], v[36:37], s[46:47]
    v_pk_mul_f32 v[38:39], v[38:39], s[46:47]
    v_pk_mul_f32 v[40:41], v[40:41], s[46:47]
    v_pk_mul_f32 v[42:43], v[42:43], s[46:47]
    v_pk_mul_f32 v[44:45], v[44:45], s[46:47]
    v_pk_mul_f32 v[46:47], v[46:47], s[46:47]
    v_pk_mul_f32 v[48:49], v[48:49], s[46:47]
    v_pk_mul_f32 v[50:51], v[50:51], s[46:47]
    v_pk_mul_f32 v[52:53], v[52:53], s[46:47]
    v_pk_mul_f32 v[54:55], v[54:55], s[46:47]
    v_pk_mul_f32 v[56:57], v[56:57], s[46:47]
    v_pk_mul_f32 v[58:59], v[58:59], s[46:47]
    v_pk_mul_f32 v[60:61], v[60:61], s[46:47]
    v_pk_mul_f32 v[62:63], v[62:63], s[46:47]
    v_pk_mul_f32 v[64:65], v[64:65], s[46:47]
    v_pk_mul_f32 v[66:67], v[66:67], s[46:47]
    v_pk_mul_f32 v[68:69], v[68:69], s[46:47]
    v_pk_mul_f32 v[70:71], v[70:71], s[46:47]
L_nosc:
    v_cvt_pk_bf16_f32 v72, v0, v1
    v_cvt_pk_bf16_f32 v73, v2, v3
    ds_write_b64 v160, v[72:73] offset:0
    v_cvt_pk_bf16_f32 v74, v4, v5
    v_cvt_pk_bf16_f32 v75, v6, v7
    ds_write_b64 v161, v[74:75] offset:0
    v_cvt_pk_bf16_f32 v76, v8, v9
    v_cvt_pk_bf16_f32 v77, v10, v11
    ds_write_b64 v162, v[76:77] offset:0
    v_cvt_pk_bf16_f32 v78, v12, v13
    v_cvt_pk_bf16_f32 v79, v14, v15
    ds_write_b64 v163, v[78:79] offset:0
    v_cvt_pk_bf16_f32 v80, v16, v17
    v_cvt_pk_bf16_f32 v81, v18, v19
    ds_write_b64 v160, v[80:81] offset:5120
    v_cvt_pk_bf16_f32 v82, v20, v21
    v_cvt_pk_bf16_f32 v83, v22, v23
    ds_write_b64 v161, v[82:83] offset:5120
    v_cvt_pk_bf16_f32 v84, v24, v25
    v_cvt_pk_bf16_f32 v85, v26, v27
    ds_write_b64 v162, v[84:85] offset:5120
    v_cvt_pk_bf16_f32 v86, v28, v29
    v_cvt_pk_bf16_f32 v87, v30, v31
    ds_write_b64 v163, v[86:87] offset:5120
    v_cvt_pk_bf16_f32 v88, v32, v33
    v_cvt_pk_bf16_f32 v89, v34, v35
    ds_write_b64 v160, v[88:89] offset:10240
    v_cvt_pk_bf16_f32 v90, v36, v37
    v_cvt_pk_bf16_f32 v91, v38, v39
    ds_write_b64 v161, v[90:91] offset:10240
    v_cvt_pk_bf16_f32 v92, v40, v41
    v_cvt_pk_bf16_f32 v93, v42, v43
    ds_write_b64 v162, v[92:93] offset:10240
    v_cvt_pk_bf16_f32 v94, v44, v45
    v_cvt_pk_bf16_f32 v95, v46, v47
    ds_write_b64 v163, v[94:95] offset:10240
    v_cvt_pk_bf16_f32 v96, v48, v49
    v_cvt_pk_bf16_f32 v97, v50, v51
    ds_write_b64 v160, v[96:97] offset:15360
    v_cvt_pk_bf16_f32 v98, v52, v53
    v_cvt_pk_bf16_f32 v99, v54, v55
    ds_write_b64 v161, v[98:99] offset:15360
    v_cvt_pk_bf16_f32 v100, v56, v57
    v_cvt_pk_bf16_f32 v101, v58, v59
    ds_write_b64 v162, v[100:101] offset:15360
    v_cvt_pk_bf16_f32 v102, v60, v61
    v_cvt_pk_bf16_f32 v103, v62, v63
    ds_write_b64 v163, v[102:103] offset:15360
    v_cvt_pk_bf16_f32 v104, v64, v65
    v_mov_b32 v105, 0x3f80
    v_cvt_pk_bf16_f32 v106, v66, v67
    v_mov_b32 v107, 0x3f80
    v_cvt_pk_bf16_f32 v108, v68, v69
    v_mov_b32 v109, 0x3f80
    v_cvt_pk_bf16_f32 v110, v70, v71
    v_mov_b32 v111, 0x3f80
    s_cmp_ge_u32 s36, 8
    s_cbranch_scc1 L_xv
    ds_write_b32 v141, v104 offset:0
    ds_write_b32 v141, v106 offset:5120
    ds_write_b32 v141, v108 offset:64
    ds_write_b32 v141, v110 offset:5184
    s_branch L_epi1
L_xv:
    ds_write_b64 v141, v[104:105] offset:0
    ds_write_b64 v141, v[106:107] offset:5120
    ds_write_b64 v141, v[108:109] offset:640
    ds_write_b64 v141, v[110:111] offset:5760
L_epi1:
    s_waitcnt vmcnt(0)
L_epi2:
    s_waitcnt lgkmcnt(0)
    s_barrier
    s_cmp_lt_u32 s24, 4
    s_cbranch_scc1 L_gapO
    s_setprio 3
    s_and_b32 s39, s24, 3
    s_mul_i32 s37, s39, 10240
    v_add_u32 v140, s37, v251
    ds_read_b128 v[160:163], v140 offset:0
    ds_read_b128 v[164:167], v140 offset:1024
    ds_read_b128 v[168:171], v140 offset:2048
    ds_read_b128 v[172:175], v140 offset:3072
    ds_read_b128 v[176:179], v140 offset:4096
    ds_read_b128 v[180:183], v140 offset:5120
    ds_read_b128 v[184:187], v140 offset:6144
    ds_read_b128 v[188:191], v140 offset:7168
    ds_read_b128 v[192:195], v140 offset:8192
    ds_read_b128 v[196:199], v140 offset:9216
    s_and_b32 s48, s36, 3
    s_lshl_b32 s48, s48, 2
    s_add_u32 s48, s48, s39
    s_lshl_b32 s48, s48, 5
    s_add_u32 s48, s48, s35
    s_mul_i32 s37, s48, 4608
    s_mul_i32 s38, s48, 9728
    s_add_u32 s38, s38, 2359296
    s_mov_b32 s49, 155648
    s_cmp_lt_u32 s36, 4
    s_cselect_b32 s37, s37, s38
    s_cselect_b32 s49, 73728, s49
    s_cmp_ge_u32 s36, 8
    s_cselect_b32 s38, 4608, 0
    s_cselect_b32 s39, -1, 0
    s_add_u32 s37, s37, s38
    s_mov_b32 s90, s37
    s_mov_b32 s91, s49
    s_mov_b32 s92, s39
    s_lshl_b32 s93, s36, 4
    s_add_u32 s93, s93, s35
    s_lshr_b32 s94, s36, 2
    s_min_u32 s94, s94, 1
    s_lshr_b32 s95, s35, 3
    s_and_b32 s94, s94, s95
    s_cmp_lg_u32 s94, 0
    s_cbranch_scc1 L_defer
    s_add_u32 s38, s90, 4096
    s_waitcnt lgkmcnt(9)
    buffer_store_dwordx4 v[160:163], v251, s[8:11], s90 offen offset:0 sc1
    s_waitcnt lgkmcnt(8)
    buffer_store_dwordx4 v[164:167], v251, s[8:11], s90 offen offset:1024 sc1
    s_waitcnt lgkmcnt(7)
    buffer_store_dwordx4 v[168:171], v251, s[8:11], s90 offen offset:2048 sc1
    s_waitcnt lgkmcnt(6)
    buffer_store_dwordx4 v[172:175], v251, s[8:11], s90 offen offset:3072 sc1
    s_mov_b32 exec_hi, s92
    s_waitcnt lgkmcnt(5)
    buffer_store_dwordx4 v[176:179], v251, s[8:11], s38 offen sc1
    s_mov_b32 exec_hi, -1
    s_add_u32 s90, s90, s91
    s_add_u32 s38, s90, 4096
    s_waitcnt lgkmcnt(4)
    buffer_store_dwordx4 v[180:183], v251, s[8:11], s90 offen offset:0 sc1
    s_waitcnt lgkmcnt(3)
    buffer_store_dwordx4 v[184:187], v251, s[8:11], s90 offen offset:1024 sc1
    s_waitcnt lgkmcnt(2)
    buffer_store_dwordx4 v[188:191], v251, s[8:11], s90 offen offset:2048 sc1
    s_waitcnt lgkmcnt(1)
    buffer_store_dwordx4 v[192:195], v251, s[8:11], s90 offen offset:3072 sc1
    s_mov_b32 exec_hi, s92
    s_waitcnt lgkmcnt(0)
    buffer_store_dwordx4 v[196:199], v251, s[8:11], s38 offen sc1
    s_mov_b32 exec_hi, -1
    s_add_u32 s90, s90, s91
    s_waitcnt vmcnt(10)
    s_cmp_eq_u32 s63, 0
    s_cbranch_scc1 L_uaa
    v_mov_b32 v140, 163792
    v_mov_b32 v141, 16
    s_mov_b64 exec, 1
    ds_add_u32 v140, v141
    s_mov_b64 exec, -1
L_uaa:
    s_lshr_b32 s37, s24, 2
    v_lshrrev_b32 v240, 5, v250
    v_bfe_u32 v241, v250, 2, 2
    v_lshl_add_u32 v240, v240, 3, v241
    s_mul_i32 s38, s37, 2560
    v_mad_u32_u24 v238, v240, 40, s38
    v_and_b32 v240, 1, v250
    v_lshlrev_b32 v240, 4, v240
    v_bfe_u32 v241, v250, 1, 1
    v_lshl_add_u32 v240, v241, 3, v240
    v_and_b32 v241, 16, v250
    v_cmp_eq_u32 vcc, 0, v241
    s_lshl_b32 s38, s37, 11
    v_add_u32 v237, s38, v251
    v_cndmask_b32 v240, 32, v240, vcc
    v_add_u32 v238, v238, v240
    v_and_b32 v240, 19, v250
    v_cmp_lt_u32 vcc, 16, v240
    v_mov_b32 v241, 0x100000
    v_mov_b32 v235, 0x3f803f80
    v_cndmask_b32 v238, v238, v241, vcc
    v_mov_b32 v233, 0
    v_mov_b32 v236, 0xdddddddd
    v_and_b32 v240, 31, v250
    s_lshl_b32 s38, s37, 8
    v_lshl_add_u32 v239, v240, 2, s38
    s_lshl_b32 s37, s31, 4
    s_lshr_b32 s38, s32, 2
    s_add_u32 s37, s37, s38
    s_mul_i32 s37, s37, 4608
    s_and_b32 s38, s32, 2
    s_lshl_b32 s54, s38, 10
    s_add_u32 s54, s54, s37
    s_lshl_b32 s55, s38, 7
    s_add_u32 s55, s55, s37
    s_add_u32 s55, s55, 4096
    s_and_b32 s56, s24, 3
    s_lshl_b32 s56, s56, 10
    s_cmp_lt_u32 s24, 4
    s_cselect_b32 s37, 40960, 0
    s_add_u32 s56, s56, s37
    s_add_u32 s57, s56, s51
    s_bfe_u32 s37, s2, 0x20005
    s_mul_i32 s37, s37, 19456
    s_add_u32 s57, s57, s37
    s_add_u32 s61, s51, 77824
    s_cmp_ge_u32 s57, s61
    s_cselect_b32 s62, 77824, 0
    s_sub_u32 s57, s57, s62
    s_waitcnt vmcnt(0)
    s_mov_b32 s30, 0
L_n1:
    v_readfirstlane_b32 s25, v253
    s_add_u32 s30, s30, 1
    s_cmp_gt_u32 s30, 65536
    s_cbranch_scc1 L_n1_d
    s_cmp_eq_u32 s25, 0
    s_cbranch_scc1 L_n1_r
    s_sub_u32 s29, s96, s25
    s_cmp_lt_i32 s29, 1000
    s_cbranch_scc1 L_n1_d
    s_cmp_gt_u32 s30, 256
    s_cbranch_scc1 L_n1_d
L_n1_r:
    v_mov_b32 v253, 0
    s_nop 0
    buffer_load_dword v253, v253, s[4:7], 0 offen sc1
    s_waitcnt vmcnt(0)
    s_branch L_n1
L_n1_d:
    v_mov_b32 v140, 163776
    v_mov_b32 v141, 1
    s_mov_b64 exec, 1
    ds_add_rtn_u32 v141, v140, v141
    s_mov_b64 exec, -1
    s_waitcnt lgkmcnt(0)
    v_readfirstlane_b32 s30, v141
    s_cmp_lg_u32 s30, 3
    s_cbranch_scc1 L_gapY
    s_lshl_b32 s26, s93, 7
    s_add_u32 s26, s26, 14417920
    v_mov_b32 v253, s25
    s_mov_b64 exec, 1
    buffer_store_dword v253, v251, s[8:11], s26 offen sc1
    s_mov_b64 exec, -1
    s_branch L_gapY
L_defer:
    s_lshr_b32 s95, s2, 8
    s_waitcnt vmcnt(0) lgkmcnt(0)
    s_cmp_eq_u32 s63, 0
    s_cbranch_scc1 L_uac
    v_mov_b32 v140, 163792
    v_mov_b32 v141, 16
    s_mov_b64 exec, 1
    ds_add_u32 v140, v141
    s_mov_b64 exec, -1
L_uac:
    s_lshr_b32 s37, s24, 2
    v_lshrrev_b32 v240, 5, v250
    v_bfe_u32 v241, v250, 2, 2
    v_lshl_add_u32 v240, v240, 3, v241
    s_mul_i32 s38, s37, 2560
    v_mad_u32_u24 v238, v240, 40, s38
    v_and_b32 v240, 1, v250
    v_lshlrev_b32 v240, 4, v240
    v_bfe_u32 v241, v250, 1, 1
    v_lshl_add_u32 v240, v241, 3, v240
    v_and_b32 v241, 16, v250
    v_cmp_eq_u32 vcc, 0, v241
    s_lshl_b32 s38, s37, 11
    v_add_u32 v237, s38, v251
    v_cndmask_b32 v240, 32, v240, vcc
    v_add_u32 v238, v238, v240
    v_and_b32 v240, 19, v250
    v_cmp_lt_u32 vcc, 16, v240
    v_mov_b32 v241, 0x100000
    v_mov_b32 v235, 0x3f803f80
    v_cndmask_b32 v238, v238, v241, vcc
    v_mov_b32 v233, 0
    v_mov_b32 v236, 0xdddddddd
    v_and_b32 v240, 31, v250
    s_lshl_b32 s38, s37, 8
    v_lshl_add_u32 v239, v240, 2, s38
    s_lshl_b32 s37, s31, 4
    s_lshr_b32 s38, s32, 2
    s_add_u32 s37, s37, s38
    s_mul_i32 s37, s37, 4608
    s_and_b32 s38, s32, 2
    s_lshl_b32 s54, s38, 10
    s_add_u32 s54, s54, s37
    s_lshl_b32 s55, s38, 7
    s_add_u32 s55, s55, s37
    s_add_u32 s55, s55, 4096
    s_and_b32 s56, s24, 3
    s_lshl_b32 s56, s56, 10
    s_cmp_lt_u32 s24, 4
    s_cselect_b32 s37, 40960, 0
    s_add_u32 s56, s56, s37
    s_add_u32 s57, s56, s51
    s_bfe_u32 s37, s2, 0x20005
    s_mul_i32 s37, s37, 19456
    s_add_u32 s57, s57, s37
    s_add_u32 s61, s51, 77824
    s_cmp_ge_u32 s57, s61
    s_cselect_b32 s62, 77824, 0
    s_sub_u32 s57, s57, s62
    s_mov_b32 s30, 0
L_n4:
    v_readfirstlane_b32 s25, v253
    s_add_u32 s30, s30, 1
    s_cmp_gt_u32 s30, 65536
    s_cbranch_scc1 L_n4_d
    s_cmp_eq_u32 s25, 0
    s_cbranch_scc1 L_n4_r
    s_sub_u32 s29, s96, s25
    s_cmp_lt_i32 s29, 1000
    s_cbranch_scc1 L_n4_d
    s_cmp_gt_u32 s30, 256
    s_cbranch_scc1 L_n4_d
L_n4_r:
    v_mov_b32 v253, 0
    s_nop 0
    buffer_load_dword v253, v253, s[4:7], 0 offen sc1
    s_waitcnt vmcnt(0)
    s_branch L_n4
L_n4_d:
    v_mov_b32 v140, 163776
    v_mov_b32 v141, 1
    s_mov_b64 exec, 1
    ds_add_u32 v140, v141
    s_mov_b64 exec, -1
    s_branch L_gapY
L_ssmwg:
    s_lshl_b32 s35, s37, 3
    s_add_u32 s35, s35, s38
    s_sub_u32 s35, s35, 24
    s_mul_i32 s37, s35, 36864
    v_lshlrev_b32 v140, 4, v252
    v_add_u32 v141, s37, v140
    v_subrev_u32 v140, 3456, v141
    s_lshl_b32 s42, s24, 10
    s_add_u32 s14, s37, 36864
    s_mov_b32 s15, 0x20000
    s_add_u32 s18, s37, 36864
    s_mov_b32 s19, 0x20000
    s_waitcnt lgkmcnt(0)
    s_mov_b64 s[12:13], s[72:73]
    s_mov_b64 s[16:17], s[74:75]
    s_add_u32 s46, s24, 0
    s_mul_i32 s46, s46, 57
    s_lshr_b32 s46, s46, 9
    s_lshl_b32 s46, s46, 5
    s_add_u32 s46, s46, s42
    s_add_u32 m0, s46, 0
    s_nop 0
    buffer_load_dwordx4 v140, s[12:15], 0 offen lds
    s_add_u32 m0, s46, 41216
    v_add_u32 v140, 8192, v140
    buffer_load_dwordx4 v141, s[16:19], 0 offen lds
    v_add_u32 v141, 8192, v141
    s_add_u32 s46, s24, 8
    s_mul_i32 s46, s46, 57
    s_lshr_b32 s46, s46, 9
    s_lshl_b32 s46, s46, 5
    s_add_u32 s46, s46, s42
    s_add_u32 m0, s46, 8192
    s_nop 0
    buffer_load_dwordx4 v140, s[12:15], 0 offen lds
    s_add_u32 m0, s46, 49408
    v_add_u32 v140, 8192, v140
    buffer_load_dwordx4 v141, s[16:19], 0 offen lds
    v_add_u32 v141, 8192, v141
    s_add_u32 s46, s24, 16
    s_mul_i32 s46, s46, 57
    s_lshr_b32 s46, s46, 9
    s_lshl_b32 s46, s46, 5
    s_add_u32 s46, s46, s42
    s_add_u32 m0, s46, 16384
    s_nop 0
    buffer_load_dwordx4 v140, s[12:15], 0 offen lds
    s_add_u32 m0, s46, 57600
    v_add_u32 v140, 8192, v140
    buffer_load_dwordx4 v141, s[16:19], 0 offen lds
    v_add_u32 v141, 8192, v141
    s_add_u32 s46, s24, 24
    s_mul_i32 s46, s46, 57
    s_lshr_b32 s46, s46, 9
    s_lshl_b32 s46, s46, 5
    s_add_u32 s46, s46, s42
    s_add_u32 m0, s46, 24576
    s_nop 0
    buffer_load_dwordx4 v140, s[12:15], 0 offen lds
    s_add_u32 m0, s46, 65792
    v_add_u32 v140, 8192, v140
    buffer_load_dwordx4 v141, s[16:19], 0 offen lds
    v_add_u32 v141, 8192, v141
    s_add_u32 s46, s24, 32
    s_mul_i32 s46, s46, 57
    s_lshr_b32 s46, s46, 9
    s_lshl_b32 s46, s46, 5
    s_add_u32 s46, s46, s42
    s_add_u32 m0, s46, 32768
    s_nop 0
    buffer_load_dwordx4 v140, s[12:15], 0 offen lds
    s_add_u32 m0, s46, 73984
    v_add_u32 v140, 8192, v140
    buffer_load_dwordx4 v141, s[16:19], 0 offen lds
    v_add_u32 v141, 8192, v141
    s_mov_b64 s[20:21], s[76:77]
    s_mov_b32 s22, 4608
    s_mov_b32 s23, 0x20000
    v_lshrrev_b32 v142, 2, v252
    v_lshlrev_b32 v143, 4, v142
    buffer_load_dwordx4 v[20:23], v143, s[20:23], 0 offen offset:0
    buffer_load_dwordx4 v[24:27], v143, s[20:23], 0 offen offset:2048
    v_add_u32 v143, 4096, v143
    buffer_load_dwordx4 v[28:31], v143, s[20:23], 0 offen
    s_mov_b64 s[8:9], s[86:87]
    s_mov_b32 s10, 14811136
    s_mov_b32 s11, 0x20000
    s_mov_b64 s[4:5], s[84:85]
    s_mov_b32 s6, 256
    s_mov_b32 s7, 0x20000
    s_and_b32 s31, s2, 7
    s_lshl_b32 s31, s31, 2
    s_bfe_u32 s26, s2, 0x20003
    s_add_u32 s31, s31, s26
    s_lshr_b32 s32, s2, 5
    s_lshl_b32 s32, s32, 3
    s_and_b32 s26, s24, 3
    s_lshl_b32 s26, s26, 1
    s_add_u32 s32, s32, s26
    s_lshr_b32 s26, s24, 2
    s_add_u32 s32, s32, s26
    s_mul_i32 s51, s31, 155648
    s_add_u32 s51, s51, 2359296
    s_lshr_b32 s26, s2, 6
    s_mul_i32 s26, s26, 144
    s_and_b32 s27, s2, 63
    s_lshl_b32 s59, s27, 1
    s_add_u32 s59, s59, s26
    s_lshr_b32 s26, s27, 4
    s_mul_i32 s26, s26, 144
    s_and_b32 s60, s27, 15
    s_add_u32 s60, s60, s26
    s_add_u32 s60, s60, 128
    s_lshl_b32 s26, s59, 1
    s_load_dword s52, s[80:81], s26
    s_lshr_b32 s26, s60, 1
    s_lshl_b32 s26, s26, 2
    s_load_dword s53, s[80:81], s26
    v_mov_b64 v[244:245], 0
    v_mov_b64 v[246:247], 0
    v_and_b32 v248, 496, v251
    v_add_u32 v248, 120832, v248
    ds_write_b128 v248, v[244:247]
    ds_write_b128 v248, v[244:247] offset:4608
    ds_write_b128 v248, v[244:247] offset:9216
    v_and_b32 v248, 48, v251
    v_add_u32 v248, 163776, v248
    ds_write_b128 v248, v[244:247]
    v_and_b32 v141, 3, v252
    v_sub_u32 v140, 3, v141
    v_mul_u32_u24 v140, 9248, v140
    v_lshl_add_u32 v140, v142, 2, v140
    v_lshlrev_b32 v142, 7, v142
    v_lshl_add_u32 v141, v141, 4, v142
    s_mul_i32 s48, s35, 36864
    s_add_u32 s48, s48, 9699328
    s_mov_b32 s44, 0
    s_waitcnt vmcnt(0) lgkmcnt(0)
    s_barrier
    v_mov_b32 v253, 0
    s_nop 0
    buffer_load_dword v253, v253, s[4:7], 0 offen sc1
L_ssml:
    ds_read_b32 v0, v140 offset:0
    ds_read_b32 v1, v140 offset:1152
    ds_read_b32 v2, v140 offset:2304
    ds_read_b32 v3, v140 offset:3456
    ds_read_b32 v4, v140 offset:4608
    ds_read_b32 v5, v140 offset:5760
    ds_read_b32 v6, v140 offset:6912
    ds_read_b32 v7, v140 offset:8064
    ds_read_b32 v8, v140 offset:9248
    ds_read_b32 v9, v140 offset:10400
    ds_read_b32 v10, v140 offset:11552
    ds_read_b32 v11, v140 offset:41216
    ds_read_b32 v12, v140 offset:42368
    ds_read_b32 v13, v140 offset:43520
    ds_read_b32 v14, v140 offset:44672
    ds_read_b32 v15, v140 offset:45824
    ds_read_b32 v16, v140 offset:46976
    ds_read_b32 v17, v140 offset:48128
    ds_read_b32 v18, v140 offset:49280
    v_lshlrev_b32 v54, 16, v20
    v_lshlrev_b32 v55, 16, v22
    v_and_b32 v56, 0xffff0000, v20
    v_and_b32 v57, 0xffff0000, v22
    v_lshlrev_b32 v58, 16, v21
    v_lshlrev_b32 v59, 16, v23
    v_and_b32 v60, 0xffff0000, v21
    v_and_b32 v61, 0xffff0000, v23
    v_mov_b64 v[20:21], v[24:25]
    v_mov_b64 v[22:23], v[26:27]
    v_mov_b64 v[24:25], v[28:29]
    v_mov_b64 v[26:27], v[30:31]
    s_waitcnt lgkmcnt(8)
    v_lshlrev_b32 v32, 16, v0
    v_and_b32 v33, 0xffff0000, v0
    v_lshlrev_b32 v34, 16, v1
    v_and_b32 v35, 0xffff0000, v1
    v_lshlrev_b32 v36, 16, v2
    v_and_b32 v37, 0xffff0000, v2
    v_lshlrev_b32 v38, 16, v3
    v_and_b32 v39, 0xffff0000, v3
    v_lshlrev_b32 v40, 16, v4
    v_and_b32 v41, 0xffff0000, v4
    v_lshlrev_b32 v42, 16, v5
    v_and_b32 v43, 0xffff0000, v5
    v_lshlrev_b32 v44, 16, v6
    v_and_b32 v45, 0xffff0000, v6
    v_lshlrev_b32 v46, 16, v7
    v_and_b32 v47, 0xffff0000, v7
    v_lshlrev_b32 v48, 16, v8
    v_and_b32 v49, 0xffff0000, v8
    v_lshlrev_b32 v50, 16, v9
    v_and_b32 v51, 0xffff0000, v9
    v_lshlrev_b32 v52, 16, v10
    v_and_b32 v53, 0xffff0000, v10
    s_waitcnt lgkmcnt(0)
    v_pk_mul_f32 v[62:63], v[32:33], v[60:61]
    v_lshlrev_b32 v78, 16, v11
    v_pk_fma_f32 v[62:63], v[34:35], v[58:59], v[62:63]
    v_and_b32 v79, 0xffff0000, v11
    v_pk_fma_f32 v[62:63], v[36:37], v[56:57], v[62:63]
    v_pk_fma_f32 v[62:63], v[38:39], v[54:55], v[62:63]
    v_pk_mul_f32 v[62:63], v[62:63], v[78:79]
    v_pk_mul_f32 v[64:65], v[34:35], v[60:61]
    v_lshlrev_b32 v80, 16, v12
    v_pk_fma_f32 v[64:65], v[36:37], v[58:59], v[64:65]
    v_and_b32 v81, 0xffff0000, v12
    v_pk_fma_f32 v[64:65], v[38:39], v[56:57], v[64:65]
    v_pk_fma_f32 v[64:65], v[40:41], v[54:55], v[64:65]
    v_pk_mul_f32 v[64:65], v[64:65], v[80:81]
    v_pk_mul_f32 v[66:67], v[36:37], v[60:61]
    v_lshlrev_b32 v78, 16, v13
    v_pk_fma_f32 v[66:67], v[38:39], v[58:59], v[66:67]
    v_and_b32 v79, 0xffff0000, v13
    v_pk_fma_f32 v[66:67], v[40:41], v[56:57], v[66:67]
    v_pk_fma_f32 v[66:67], v[42:43], v[54:55], v[66:67]
    v_pk_mul_f32 v[66:67], v[66:67], v[78:79]
    v_pk_mul_f32 v[68:69], v[38:39], v[60:61]
    v_lshlrev_b32 v80, 16, v14
    v_pk_fma_f32 v[68:69], v[40:41], v[58:59], v[68:69]
    v_and_b32 v81, 0xffff0000, v14
    v_pk_fma_f32 v[68:69], v[42:43], v[56:57], v[68:69]
    v_pk_fma_f32 v[68:69], v[44:45], v[54:55], v[68:69]
    v_pk_mul_f32 v[68:69], v[68:69], v[80:81]
    v_pk_mul_f32 v[70:71], v[40:41], v[60:61]
    v_lshlrev_b32 v78, 16, v15
    v_pk_fma_f32 v[70:71], v[42:43], v[58:59], v[70:71]
    v_and_b32 v79, 0xffff0000, v15
    v_pk_fma_f32 v[70:71], v[44:45], v[56:57], v[70:71]
    v_pk_fma_f32 v[70:71], v[46:47], v[54:55], v[70:71]
    v_pk_mul_f32 v[70:71], v[70:71], v[78:79]
    v_pk_mul_f32 v[72:73], v[42:43], v[60:61]
    v_lshlrev_b32 v80, 16, v16
    v_pk_fma_f32 v[72:73], v[44:45], v[58:59], v[72:73]
    v_and_b32 v81, 0xffff0000, v16
    v_pk_fma_f32 v[72:73], v[46:47], v[56:57], v[72:73]
    v_pk_fma_f32 v[72:73], v[48:49], v[54:55], v[72:73]
    v_pk_mul_f32 v[72:73], v[72:73], v[80:81]
    v_pk_mul_f32 v[74:75], v[44:45], v[60:61]
    v_lshlrev_b32 v78, 16, v17
    v_pk_fma_f32 v[74:75], v[46:47], v[58:59], v[74:75]
    v_and_b32 v79, 0xffff0000, v17
    v_pk_fma_f32 v[74:75], v[48:49], v[56:57], v[74:75]
    v_pk_fma_f32 v[74:75], v[50:51], v[54:55], v[74:75]
    v_pk_mul_f32 v[74:75], v[74:75], v[78:79]
    v_pk_mul_f32 v[76:77], v[46:47], v[60:61]
    v_lshlrev_b32 v80, 16, v18
    v_pk_fma_f32 v[76:77], v[48:49], v[58:59], v[76:77]
    v_and_b32 v81, 0xffff0000, v18
    v_pk_fma_f32 v[76:77], v[50:51], v[56:57], v[76:77]
    v_pk_fma_f32 v[76:77], v[52:53], v[54:55], v[76:77]
    v_pk_mul_f32 v[76:77], v[76:77], v[80:81]
    v_cvt_pk_bf16_f32 v84, v76, v74
    v_cvt_pk_bf16_f32 v85, v72, v70
    v_cvt_pk_bf16_f32 v86, v68, v66
    v_cvt_pk_bf16_f32 v87, v64, v62
    v_cvt_pk_bf16_f32 v88, v77, v75
    v_cvt_pk_bf16_f32 v89, v73, v71
    v_cvt_pk_bf16_f32 v90, v69, v67
    v_cvt_pk_bf16_f32 v91, v65, v63
    buffer_store_dwordx4 v[84:87], v141, s[8:11], s48 offen sc1
    buffer_store_dwordx4 v[88:91], v141, s[8:11], s48 offen offset:64 sc1
    v_add_u32 v140, 512, v140
    s_add_u32 s48, s48, 16384
    s_add_u32 s44, s44, 1
    s_cmp_lt_u32 s44, 2
    s_cbranch_scc1 L_ssml
    s_cmp_eq_u32 s44, 3
    s_cbranch_scc1 L_ssmd
    s_cmp_lt_u32 s24, 2
    s_cbranch_scc1 L_ssml
L_ssmd:
    s_waitcnt vmcnt(0)
    s_barrier
    s_cmp_lt_u32 s24, 4
    s_cbranch_scc1 L_gapO
    s_mov_b32 s30, 0
L_n2:
    v_readfirstlane_b32 s25, v253
    s_add_u32 s30, s30, 1
    s_cmp_gt_u32 s30, 65536
    s_cbranch_scc1 L_n2_d
    s_cmp_eq_u32 s25, 0
    s_cbranch_scc1 L_n2_r
    s_sub_u32 s29, s96, s25
    s_cmp_lt_i32 s29, 1000
    s_cbranch_scc1 L_n2_d
    s_cmp_gt_u32 s30, 256
    s_cbranch_scc1 L_n2_d
L_n2_r:
    v_mov_b32 v253, 0
    s_nop 0
    buffer_load_dword v253, v253, s[4:7], 0 offen sc1
    s_waitcnt vmcnt(0)
    s_branch L_n2
L_n2_d:
    s_cmp_lg_u32 s24, 4
    s_cbranch_scc1 L_sd2
    s_lshl_b32 s26, s35, 7
    s_add_u32 s26, s26, 14450688
    v_mov_b32 v253, s25
    s_mov_b64 exec, 1
    buffer_store_dword v253, v251, s[8:11], s26 offen sc1
    s_mov_b64 exec, -1
L_sd2:
    s_lshr_b32 s94, s2, 8
    s_lshr_b32 s95, s2, 8
    s_mov_b64 s[20:21], s[78:79]
    s_mov_b32 s22, 2359296
    s_mov_b32 s23, 0x20000
    s_and_b32 s26, s24, 3
    s_lshl_b32 s26, s26, 10
    s_lshl_b32 s27, s59, 12
    s_lshl_b32 s29, s60, 12
    v_mov_b32 v141, s29
    v_lshlrev_b32 v140, 11, v250
    v_and_b32 v140, 4096, v140
    v_cmp_gt_u32 vcc, 4, v250
    v_add_u32 v140, s27, v140
    s_add_u32 s27, s27, s26
    s_add_u32 s28, s27, 4096
    s_add_u32 s29, s29, s26
    v_cndmask_b32 v140, v141, v140, vcc
    v_mov_b32 v253, 0
    s_add_u32 m0, s26, 134752
    s_nop 0
    buffer_load_dwordx4 v251, s[20:23], s27 offen lds
    s_add_u32 m0, s26, 143072
    s_nop 0
    buffer_load_dwordx4 v251, s[20:23], s28 offen lds
    s_add_u32 m0, s26, 151392
    s_nop 0
    buffer_load_dwordx4 v251, s[20:23], s29 offen lds
    s_add_u32 m0, s26, 130592
    s_add_u32 s27, s27, 2
    buffer_load_dwordx4 v251, s[20:23], s27 offen lds
    s_add_u32 m0, s26, 138912
    s_add_u32 s28, s28, 2
    buffer_load_dwordx4 v251, s[20:23], s28 offen lds
    s_add_u32 m0, s26, 147232
    s_add_u32 s29, s29, 2
    buffer_load_dwordx4 v251, s[20:23], s29 offen lds
    buffer_load_dword v249, v140, s[20:23], 0 offen
    buffer_load_dword v253, v253, s[4:7], 0 offen sc1
    s_lshr_b32 s37, s24, 2
    v_lshrrev_b32 v240, 5, v250
    v_bfe_u32 v241, v250, 2, 2
    v_lshl_add_u32 v240, v240, 3, v241
    s_mul_i32 s38, s37, 2560
    v_mad_u32_u24 v238, v240, 40, s38
    v_and_b32 v240, 1, v250
    v_lshlrev_b32 v240, 4, v240
    v_bfe_u32 v241, v250, 1, 1
    v_lshl_add_u32 v240, v241, 3, v240
    v_and_b32 v241, 16, v250
    v_cmp_eq_u32 vcc, 0, v241
    s_lshl_b32 s38, s37, 11
    v_add_u32 v237, s38, v251
    v_cndmask_b32 v240, 32, v240, vcc
    v_add_u32 v238, v238, v240
    v_and_b32 v240, 19, v250
    v_cmp_lt_u32 vcc, 16, v240
    v_mov_b32 v241, 0x100000
    v_mov_b32 v235, 0x3f803f80
    v_cndmask_b32 v238, v238, v241, vcc
    v_mov_b32 v233, 0
    v_mov_b32 v236, 0xdddddddd
    v_and_b32 v240, 31, v250
    s_lshl_b32 s38, s37, 8
    v_lshl_add_u32 v239, v240, 2, s38
    s_lshl_b32 s37, s31, 4
    s_lshr_b32 s38, s32, 2
    s_add_u32 s37, s37, s38
    s_mul_i32 s37, s37, 4608
    s_and_b32 s38, s32, 2
    s_lshl_b32 s54, s38, 10
    s_add_u32 s54, s54, s37
    s_lshl_b32 s55, s38, 7
    s_add_u32 s55, s55, s37
    s_add_u32 s55, s55, 4096
    s_and_b32 s56, s24, 3
    s_lshl_b32 s56, s56, 10
    s_cmp_lt_u32 s24, 4
    s_cselect_b32 s37, 40960, 0
    s_add_u32 s56, s56, s37
    s_add_u32 s57, s56, s51
    s_bfe_u32 s37, s2, 0x20005
    s_mul_i32 s37, s37, 19456
    s_add_u32 s57, s57, s37
    s_add_u32 s61, s51, 77824
    s_cmp_ge_u32 s57, s61
    s_cselect_b32 s62, 77824, 0
    s_sub_u32 s57, s57, s62
    s_waitcnt vmcnt(0)
    s_cmp_lg_u32 s24, 7
    s_cbranch_scc1 L_hfb
    v_mul_u32_u24 v140, 4160, v250
    v_and_b32 v141, 1, v250
    v_cmp_eq_u32 vcc, 0, v141
    v_mov_b64 v[240:241], 0
    v_mov_b64 v[242:243], 0
    v_mov_b64 v[244:245], 0
    v_mov_b32 v246, 0
    v_lshlrev_b32 v141, 16, v249
    v_cndmask_b32 v247, 0, v141, vcc
    v_add_u32 v140, 130560, v140
    s_mov_b64 exec, 63
    ds_write_b128 v140, v[240:243]
    ds_write_b128 v140, v[244:247] offset:16
    s_mov_b64 exec, -1
L_hfb:
    v_mov_b32 v142, 163792
    v_mov_b32 v143, 1
    s_mov_b64 exec, 1
    ds_add_u32 v142, v143
    s_mov_b64 exec, -1
    v_mov_b32 v140, 163776
    v_mov_b32 v141, 1
    s_mov_b64 exec, 1
    ds_add_u32 v140, v141
    s_mov_b64 exec, -1
L_gapY:
    s_lshr_b32 s99, s2, 8
    v_mov_b32 v224, 0
    s_cmp_lt_u32 s2, 192
    s_cbranch_scc1 L_gy0
    s_cmp_lt_u32 s24, 6
    s_cbranch_scc1 L_gy0
    s_setprio 2
    s_branch L_cvin
L_gy0:
    s_setprio 3
    s_and_b32 s43, s24, 3
    s_cmp_lg_u32 s24, 4
    s_cbranch_scc1 L_gy2
    s_lshr_b32 s37, s31, 3
    v_lshrrev_b32 v140, 4, v250
    v_add_u32 v141, 1, v140
    v_cmp_gt_u32 vcc, 32, v250
    v_and_b32 v142, 7, v250
    v_and_b32 v143, 1, v250
    v_cndmask_b32 v141, 0, v141, vcc
    v_lshl_add_u32 v141, v141, 2, s37
    s_lshr_b32 s37, s2, 5
    s_lshl_b32 s37, s37, 1
    v_add_u32 v143, s37, v143
    v_cndmask_b32 v142, v143, v142, vcc
    v_lshl_add_u32 v142, v141, 4, v142
    v_lshlrev_b32 v142, 7, v142
    s_mov_b32 s28, 14417920
    s_mov_b32 s30, 0
L_s1_poll:
    buffer_load_dword v140, v142, s[8:11], s28 offen sc1
    s_waitcnt vmcnt(0)
    v_xor_b32 v140, s25, v140
    v_cmp_ne_u32 vcc, 0, v140
    s_add_u32 s30, s30, 1
    s_cmp_gt_u32 s30, 65536
    s_cbranch_scc1 L_s1_pdone
    s_cmp_eq_u64 vcc, 0
    s_cbranch_scc1 L_s1_pdone
    s_sleep 2
    s_branch L_s1_poll
L_s1_pdone:
    v_mov_b32 v140, 163808
    v_mov_b32 v141, 1
    s_mov_b64 exec, 1
    ds_add_u32 v140, v141
    s_mov_b64 exec, -1
L_gy2:
    v_mov_b32 v140, 163808
    s_branch L_spF1
L_spF1_s:
    s_sleep 1
L_spF1:
    ds_read_b32 v141, v140
    s_waitcnt lgkmcnt(0)
    v_readfirstlane_b32 s30, v141
    s_cmp_lt_u32 s30, 1
    s_cbranch_scc1 L_spF1_s
    v_mov_b32 v140, 163776
    s_branch L_spS
L_spS_s:
    s_sleep 1
L_spS:
    ds_read_b32 v141, v140
    s_waitcnt lgkmcnt(0)
    v_readfirstlane_b32 s30, v141
    s_cmp_lt_u32 s30, 4
    s_cbranch_scc1 L_spS_s
    s_mov_b32 m0, s56
    s_add_u32 s56, s56, 4096
    buffer_load_dwordx4 v251, s[8:11], s57 offen sc1 lds
    s_add_u32 s57, s57, 4096
    s_cmp_ge_u32 s57, s61
    s_cselect_b32 s62, 77824, 0
    s_sub_u32 s57, s57, s62
    s_mov_b32 m0, s56
    s_add_u32 s56, s56, 4096
    buffer_load_dwordx4 v251, s[8:11], s57 offen sc1 lds
    s_add_u32 s57, s57, 4096
    s_cmp_ge_u32 s57, s61
    s_cselect_b32 s62, 77824, 0
    s_sub_u32 s57, s57, s62
    s_mul_i32 s37, s43, 2304
    s_add_u32 m0, s37, 98304
    v_lshlrev_b32 v140, 2, v250
    buffer_load_dwordx4 v251, s[8:11], s54 offen sc1 lds
    buffer_load_dwordx4 v251, s[8:11], s54 offen offset:1024 sc1 lds
    s_add_u32 m0, s37, 100352
    s_nop 0
    buffer_load_dword v140, s[8:11], s55 offen sc1 lds
    s_mov_b32 m0, s56
    s_add_u32 s56, s56, 4096
    buffer_load_dwordx4 v251, s[8:11], s57 offen sc1 lds
    s_add_u32 s57, s57, 4096
    s_cmp_ge_u32 s57, s61
    s_cselect_b32 s62, 77824, 0
    s_sub_u32 s57, s57, s62
    s_mov_b32 m0, s56
    s_add_u32 s56, s56, 4096
    buffer_load_dwordx4 v251, s[8:11], s57 offen sc1 lds
    s_add_u32 s57, s57, 4096
    s_cmp_ge_u32 s57, s61
    s_cselect_b32 s62, 77824, 0
    s_sub_u32 s57, s57, s62
    s_mov_b32 m0, s56
    s_add_u32 s56, s56, 4096
    buffer_load_dwordx4 v251, s[8:11], s57 offen sc1 lds
    s_add_u32 s57, s57, 4096
    s_cmp_ge_u32 s57, s61
    s_cselect_b32 s62, 77824, 0
    s_sub_u32 s57, s57, s62
    s_mov_b32 m0, s56
    s_add_u32 s56, s56, 4096
    buffer_load_dwordx4 v251, s[8:11], s57 offen sc1 lds
    s_add_u32 s57, s57, 4096
    s_cmp_ge_u32 s57, s61
    s_cselect_b32 s62, 77824, 0
    s_sub_u32 s57, s57, s62
    s_mov_b32 m0, s56
    s_add_u32 s56, s56, 4096
    buffer_load_dwordx4 v251, s[8:11], s57 offen sc1 lds
    s_add_u32 s57, s57, 4096
    s_cmp_ge_u32 s57, s61
    s_cselect_b32 s62, 77824, 0
    s_sub_u32 s57, s57, s62
    s_mov_b32 m0, s56
    s_add_u32 s56, s56, 4096
    buffer_load_dwordx4 v251, s[8:11], s57 offen sc1 lds
    s_add_u32 s57, s57, 4096
    s_cmp_ge_u32 s57, s61
    s_cselect_b32 s62, 77824, 0
    s_sub_u32 s57, s57, s62
    s_mov_b32 m0, s56
    s_add_u32 s56, s56, 4096
    buffer_load_dwordx4 v251, s[8:11], s57 offen sc1 lds
    s_add_u32 s57, s57, 4096
    s_cmp_ge_u32 s57, s61
    s_cselect_b32 s62, 77824, 0
    s_sub_u32 s57, s57, s62
    s_mov_b32 m0, s56
    s_add_u32 s56, s56, 4096
    buffer_load_dwordx4 v251, s[8:11], s57 offen sc1 lds
    s_add_u32 s57, s57, 4096
    s_cmp_ge_u32 s57, s61
    s_cselect_b32 s62, 77824, 0
    s_sub_u32 s57, s57, s62
    s_waitcnt vmcnt(8)
    v_mov_b32 v140, 163828
    v_mov_b32 v141, 1
    s_mov_b64 exec, 1
    ds_add_u32 v140, v141
    s_mov_b64 exec, -1
    s_branch L_e2
L_gapO:
    s_waitcnt vmcnt(0)
    s_mov_b32 s30, 0
L_n3:
    v_readfirstlane_b32 s25, v253
    s_add_u32 s30, s30, 1
    s_cmp_gt_u32 s30, 65536
    s_cbranch_scc1 L_n3_d
    s_cmp_eq_u32 s25, 0
    s_cbranch_scc1 L_n3_r
    s_sub_u32 s29, s96, s25
    s_cmp_lt_i32 s29, 1000
    s_cbranch_scc1 L_n3_d
    s_cmp_gt_u32 s30, 256
    s_cbranch_scc1 L_n3_d
L_n3_r:
    v_mov_b32 v253, 0
    s_nop 0
    buffer_load_dword v253, v253, s[4:7], 0 offen sc1
    s_waitcnt vmcnt(0)
    s_branch L_n3
L_n3_d:
    s_cmp_lg_u32 s24, 0
    s_cbranch_scc1 L_go1
    v_mov_b32 v34, 163836
    ds_read_b32 v35, v34
    s_mov_b32 s27, 14450688
    v_lshlrev_b32 v34, 7, v250
    s_waitcnt lgkmcnt(0)
    v_readfirstlane_b32 s63, v35
    s_cmp_eq_u32 s63, 4
    s_cbranch_scc1 L_go1
    s_mov_b32 s30, 0
L_su_poll:
    buffer_load_dword v35, v34, s[8:11], s27 offen sc1
    s_waitcnt vmcnt(0)
    v_xor_b32 v35, s25, v35
    v_cmp_ne_u32 vcc, 0, v35
    s_add_u32 s30, s30, 1
    s_cmp_gt_u32 s30, 65536
    s_cbranch_scc1 L_su_pdone
    s_cmp_eq_u64 vcc, 0
    s_cbranch_scc1 L_su_pdone
    s_sleep 2
    s_branch L_su_poll
L_su_pdone:
    v_lshrrev_b32 v34, 2, v250
    v_sub_u32 v34, 15, v34
    v_mul_u32_u24 v34, 36864, v34
    v_and_b32 v35, 48, v251
    v_add_u32 v34, v34, v35
    s_lshl_b32 s26, s59, 6
    s_lshl_b32 s28, s60, 6
    s_mov_b32 m0, 125952
    s_add_u32 s29, s28, 11468800
    buffer_load_dwordx4 v34, s[8:11], s29 offen sc1 lds
    s_mov_b32 m0, 126976
    s_add_u32 s29, s28, 10878976
    buffer_load_dwordx4 v34, s[8:11], s29 offen sc1 lds
    s_mov_b32 m0, 128000
    s_add_u32 s29, s28, 10289152
    buffer_load_dwordx4 v34, s[8:11], s29 offen sc1 lds
    s_mov_b32 m0, 129024
    s_add_u32 s29, s28, 9699328
    buffer_load_dwordx4 v34, s[8:11], s29 offen sc1 lds
    s_mov_b32 m0, 116736
    s_add_u32 s29, s26, 11468800
    buffer_load_dwordx4 v34, s[8:11], s29 offen sc1 lds
    s_mov_b32 m0, 117760
    s_add_u32 s29, s26, 10878976
    buffer_load_dwordx4 v34, s[8:11], s29 offen sc1 lds
    s_mov_b32 m0, 118784
    s_add_u32 s29, s26, 10289152
    buffer_load_dwordx4 v34, s[8:11], s29 offen sc1 lds
    s_mov_b32 m0, 119808
    s_add_u32 s29, s26, 9699328
    buffer_load_dwordx4 v34, s[8:11], s29 offen sc1 lds
    s_mov_b32 m0, 121344
    s_add_u32 s29, s26, 11468864
    buffer_load_dwordx4 v34, s[8:11], s29 offen sc1 lds
    s_mov_b32 m0, 122368
    s_add_u32 s29, s26, 10879040
    buffer_load_dwordx4 v34, s[8:11], s29 offen sc1 lds
    s_mov_b32 m0, 123392
    s_add_u32 s29, s26, 10289216
    buffer_load_dwordx4 v34, s[8:11], s29 offen sc1 lds
    s_mov_b32 m0, 124416
    s_add_u32 s29, s26, 9699392
    buffer_load_dwordx4 v34, s[8:11], s29 offen sc1 lds
L_go1:
    s_lshr_b32 s37, s24, 2
    v_lshrrev_b32 v240, 5, v250
    v_bfe_u32 v241, v250, 2, 2
    v_lshl_add_u32 v240, v240, 3, v241
    s_mul_i32 s38, s37, 2560
    v_mad_u32_u24 v238, v240, 40, s38
    v_and_b32 v240, 1, v250
    v_lshlrev_b32 v240, 4, v240
    v_bfe_u32 v241, v250, 1, 1
    v_lshl_add_u32 v240, v241, 3, v240
    v_and_b32 v241, 16, v250
    v_cmp_eq_u32 vcc, 0, v241
    s_lshl_b32 s38, s37, 11
    v_add_u32 v237, s38, v251
    v_cndmask_b32 v240, 32, v240, vcc
    v_add_u32 v238, v238, v240
    v_and_b32 v240, 19, v250
    v_cmp_lt_u32 vcc, 16, v240
    v_mov_b32 v241, 0x100000
    v_mov_b32 v235, 0x3f803f80
    v_cndmask_b32 v238, v238, v241, vcc
    v_mov_b32 v233, 0
    v_mov_b32 v236, 0xdddddddd
    v_and_b32 v240, 31, v250
    s_lshl_b32 s38, s37, 8
    v_lshl_add_u32 v239, v240, 2, s38
    s_lshl_b32 s37, s31, 4
    s_lshr_b32 s38, s32, 2
    s_add_u32 s37, s37, s38
    s_mul_i32 s37, s37, 4608
    s_and_b32 s38, s32, 2
    s_lshl_b32 s54, s38, 10
    s_add_u32 s54, s54, s37
    s_lshl_b32 s55, s38, 7
    s_add_u32 s55, s55, s37
    s_add_u32 s55, s55, 4096
    s_and_b32 s56, s24, 3
    s_lshl_b32 s56, s56, 10
    s_cmp_lt_u32 s24, 4
    s_cselect_b32 s37, 40960, 0
    s_add_u32 s56, s56, s37
    s_add_u32 s57, s56, s51
    s_bfe_u32 s37, s2, 0x20005
    s_mul_i32 s37, s37, 19456
    s_add_u32 s57, s57, s37
    s_add_u32 s61, s51, 77824
    s_cmp_ge_u32 s57, s61
    s_cselect_b32 s62, 77824, 0
    s_sub_u32 s57, s57, s62
L_cvin:
    s_lshr_b32 s37, s24, 1
    s_min_u32 s37, s37, 2
    s_add_u32 s44, s59, s37
    s_cmp_eq_u32 s37, 2
    s_cselect_b32 s44, s60, s44
    s_cselect_b32 s52, s53, s52
    s_mul_i32 s40, s37, 8320
    s_add_u32 s40, s40, 130560
    s_mul_i32 s39, s37, 4608
    s_add_u32 s39, s39, 116736
    s_mov_b32 s38, s39
    v_and_b32 v34, 15, v250
    v_lshrrev_b32 v35, 4, v250
    v_lshlrev_b32 v36, 1, v34
    v_lshl_add_u32 v37, v35, 4, v36
    v_and_b32 v36, 1, v34
    v_mul_u32_u24 v36, 4162, v36
    v_add3_u32 v32, v37, v36, s40
    v_sub_u32 v36, 15, v34
    v_lshlrev_b32 v36, 5, v36
    v_lshl_add_u32 v38, v35, 4, v36
    v_add_u32 v33, s38, v38
    v_lshlrev_b32 v36, 3, v35
    v_lshl_add_u32 v36, v34, 5, v36
    v_lshrrev_b32 v34, 1, v34
    v_mul_u32_u24 v34, 36864, v34
    v_and_or_b32 v34, v36, 63, v34
    v_add_u32 v39, 1024, v32
    v_add_u32 v40, 2048, v32
    v_add_u32 v41, 3072, v32
    s_cmp_lg_u32 s24, 0
    s_cbranch_scc1 L_go2
    s_cmp_eq_u32 s63, 4
    s_cbranch_scc1 L_go2
    s_lshl_b32 s63, s63, 4
    s_sub_u32 s63, 64, s63
    v_mov_b32 v42, 163792
    v_mov_b32 v43, s63
    s_waitcnt vmcnt(0)
    s_mov_b64 exec, 1
    ds_add_u32 v42, v43
    s_mov_b64 exec, -1
L_go2:
    v_mov_b32 v42, 163792
    s_branch L_spU
L_spU_s:
    s_sleep 1
L_spU:
    ds_read_b32 v43, v42
    s_waitcnt lgkmcnt(0)
    v_readfirstlane_b32 s30, v43
    s_cmp_lt_u32 s30, 68
    s_cbranch_scc1 L_spU_s
    s_bitcmp1_b32 s24, 0
    s_cbranch_scc1 L_set1
    ds_read2_b32 v[44:45], v32 offset0:0 offset1:1
    ds_read2_b32 v[46:47], v32 offset0:2 offset1:3
    ds_read_b128 v[104:107], v33 offset:0
    ds_read2_b32 v[48:49], v32 offset0:128 offset1:129
    ds_read2_b32 v[50:51], v32 offset0:130 offset1:131
    ds_read_b128 v[100:103], v33 offset:512
    ds_read2_b32 v[52:53], v39 offset0:0 offset1:1
    ds_read2_b32 v[54:55], v39 offset0:2 offset1:3
    ds_read_b128 v[96:99], v33 offset:1024
    ds_read2_b32 v[56:57], v39 offset0:128 offset1:129
    ds_read2_b32 v[58:59], v39 offset0:130 offset1:131
    ds_read_b128 v[92:95], v33 offset:1536
    v_mov_b64 v[120:121], 0
    v_mov_b64 v[122:123], 0
    v_mov_b64 v[124:125], 0
    v_mov_b64 v[126:127], 0
    v_mov_b64 v[128:129], 0
    v_mov_b64 v[130:131], 0
    v_mov_b64 v[132:133], 0
    v_mov_b64 v[134:135], 0
    s_mov_b32 s42, 0
L_cl0:
    s_waitcnt lgkmcnt(9)
    v_mfma_f32_16x16x32_bf16 v[120:123], v[44:47], v[104:107], v[120:123]
    ds_read2_b32 v[60:61], v40 offset0:0 offset1:1
    ds_read2_b32 v[62:63], v40 offset0:2 offset1:3
    ds_read_b128 v[88:91], v33 offset:2048
    s_waitcnt lgkmcnt(9)
    v_mfma_f32_16x16x32_bf16 v[120:123], v[48:51], v[100:103], v[120:123]
    ds_read2_b32 v[64:65], v40 offset0:128 offset1:129
    ds_read2_b32 v[66:67], v40 offset0:130 offset1:131
    v_mfma_f32_16x16x32_bf16 v[124:127], v[44:47], v[100:103], v[124:127]
    ds_read_b128 v[84:87], v33 offset:2560
    s_waitcnt lgkmcnt(9)
    v_mfma_f32_16x16x32_bf16 v[120:123], v[52:55], v[96:99], v[120:123]
    ds_read2_b32 v[68:69], v41 offset0:0 offset1:1
    ds_read2_b32 v[70:71], v41 offset0:2 offset1:3
    v_mfma_f32_16x16x32_bf16 v[124:127], v[48:51], v[96:99], v[124:127]
    ds_read_b128 v[80:83], v33 offset:3072
    s_waitcnt lgkmcnt(9)
    v_mfma_f32_16x16x32_bf16 v[120:123], v[56:59], v[92:95], v[120:123]
    ds_read2_b32 v[72:73], v41 offset0:128 offset1:129
    ds_read2_b32 v[74:75], v41 offset0:130 offset1:131
    v_mfma_f32_16x16x32_bf16 v[124:127], v[52:55], v[92:95], v[124:127]
    ds_read_b128 v[76:79], v33 offset:3584
    s_waitcnt lgkmcnt(9)
    v_mfma_f32_16x16x32_bf16 v[120:123], v[60:63], v[88:91], v[120:123]
    ds_read2_b32 v[200:201], v32 offset0:16 offset1:17
    ds_read2_b32 v[202:203], v32 offset0:18 offset1:19
    v_mfma_f32_16x16x32_bf16 v[124:127], v[56:59], v[88:91], v[124:127]
    ds_read_b128 v[28:31], v33 offset:64
    s_waitcnt lgkmcnt(9)
    v_mfma_f32_16x16x32_bf16 v[120:123], v[64:67], v[84:87], v[120:123]
    ds_read2_b32 v[204:205], v32 offset0:144 offset1:145
    ds_read2_b32 v[206:207], v32 offset0:146 offset1:147
    v_mfma_f32_16x16x32_bf16 v[124:127], v[60:63], v[84:87], v[124:127]
    ds_read_b128 v[24:27], v33 offset:576
    s_waitcnt lgkmcnt(9)
    v_mfma_f32_16x16x32_bf16 v[120:123], v[68:71], v[80:83], v[120:123]
    ds_read2_b32 v[208:209], v39 offset0:16 offset1:17
    ds_read2_b32 v[210:211], v39 offset0:18 offset1:19
    v_mfma_f32_16x16x32_bf16 v[124:127], v[64:67], v[80:83], v[124:127]
    ds_read_b128 v[20:23], v33 offset:1088
    v_mfma_f32_16x16x32_bf16 v[128:131], v[44:47], v[80:83], v[128:131]
    s_waitcnt lgkmcnt(9)
    v_mfma_f32_16x16x32_bf16 v[120:123], v[72:75], v[76:79], v[120:123]
    ds_read2_b32 v[212:213], v39 offset0:144 offset1:145
    ds_read2_b32 v[214:215], v39 offset0:146 offset1:147
    v_mfma_f32_16x16x32_bf16 v[124:127], v[68:71], v[76:79], v[124:127]
    ds_read_b128 v[16:19], v33 offset:1600
    v_mfma_f32_16x16x32_bf16 v[128:131], v[48:51], v[76:79], v[128:131]
    v_mfma_f32_16x16x32_bf16 v[132:135], v[44:47], v[76:79], v[132:135]
    s_waitcnt lgkmcnt(9)
    v_mfma_f32_16x16x32_bf16 v[120:123], v[200:203], v[28:31], v[120:123]
    ds_read2_b32 v[216:217], v40 offset0:16 offset1:17
    ds_read2_b32 v[218:219], v40 offset0:18 offset1:19
    ds_read_b128 v[12:15], v33 offset:2112
    s_waitcnt lgkmcnt(9)
    v_mfma_f32_16x16x32_bf16 v[120:123], v[204:207], v[24:27], v[120:123]
    ds_read2_b32 v[220:221], v40 offset0:144 offset1:145
    ds_read2_b32 v[222:223], v40 offset0:146 offset1:147
    v_mfma_f32_16x16x32_bf16 v[124:127], v[200:203], v[24:27], v[124:127]
    ds_read_b128 v[8:11], v33 offset:2624
    s_waitcnt lgkmcnt(9)
    v_mfma_f32_16x16x32_bf16 v[120:123], v[208:211], v[20:23], v[120:123]
    ds_read2_b32 v[224:225], v41 offset0:16 offset1:17
    ds_read2_b32 v[226:227], v41 offset0:18 offset1:19
    v_mfma_f32_16x16x32_bf16 v[124:127], v[204:207], v[20:23], v[124:127]
    ds_read_b128 v[4:7], v33 offset:3136
    s_waitcnt lgkmcnt(9)
    v_mfma_f32_16x16x32_bf16 v[120:123], v[212:215], v[16:19], v[120:123]
    ds_read2_b32 v[228:229], v41 offset0:144 offset1:145
    ds_read2_b32 v[230:231], v41 offset0:146 offset1:147
    v_mfma_f32_16x16x32_bf16 v[124:127], v[208:211], v[16:19], v[124:127]
    ds_read_b128 v[0:3], v33 offset:3648
    s_waitcnt lgkmcnt(9)
    v_mfma_f32_16x16x32_bf16 v[120:123], v[216:219], v[12:15], v[120:123]
    ds_read2_b32 v[44:45], v32 offset0:32 offset1:33
    ds_read2_b32 v[46:47], v32 offset0:34 offset1:35
    v_mfma_f32_16x16x32_bf16 v[124:127], v[212:215], v[12:15], v[124:127]
    ds_read_b128 v[104:107], v33 offset:128
    s_waitcnt lgkmcnt(9)
    v_mfma_f32_16x16x32_bf16 v[120:123], v[220:223], v[8:11], v[120:123]
    ds_read2_b32 v[48:49], v32 offset0:160 offset1:161
    ds_read2_b32 v[50:51], v32 offset0:162 offset1:163
    v_mfma_f32_16x16x32_bf16 v[124:127], v[216:219], v[8:11], v[124:127]
    ds_read_b128 v[100:103], v33 offset:640
    s_waitcnt lgkmcnt(9)
    v_mfma_f32_16x16x32_bf16 v[120:123], v[224:227], v[4:7], v[120:123]
    ds_read2_b32 v[52:53], v39 offset0:32 offset1:33
    ds_read2_b32 v[54:55], v39 offset0:34 offset1:35
    v_mfma_f32_16x16x32_bf16 v[124:127], v[220:223], v[4:7], v[124:127]
    ds_read_b128 v[96:99], v33 offset:1152
    v_mfma_f32_16x16x32_bf16 v[128:131], v[200:203], v[4:7], v[128:131]
    s_waitcnt lgkmcnt(9)
    v_mfma_f32_16x16x32_bf16 v[120:123], v[228:231], v[0:3], v[120:123]
    ds_read2_b32 v[56:57], v39 offset0:160 offset1:161
    ds_read2_b32 v[58:59], v39 offset0:162 offset1:163
    v_mfma_f32_16x16x32_bf16 v[124:127], v[224:227], v[0:3], v[124:127]
    ds_read_b128 v[92:95], v33 offset:1664
    v_mfma_f32_16x16x32_bf16 v[128:131], v[204:207], v[0:3], v[128:131]
    v_mfma_f32_16x16x32_bf16 v[132:135], v[200:203], v[0:3], v[132:135]
    v_add_u32 v32, 128, v32
    v_add_u32 v33, 128, v33
    v_add_u32 v39, 128, v39
    v_add_u32 v40, 128, v40
    v_add_u32 v41, 128, v41
    s_add_u32 s42, s42, 1
    s_cmp_lt_u32 s42, 4
    s_cbranch_scc1 L_cl0
    v_sub_u32 v32, 504, v36
    v_add_u32 v32, s39, v32
    ds_read_b64 v[200:201], v32 offset:0
    ds_read_b64 v[202:203], v32 offset:512
    ds_read_b64 v[204:205], v32 offset:3072
    ds_read_b64 v[206:207], v32 offset:3584
    s_lshl_b32 s37, s52, 16
    s_and_b32 s38, s52, 0xffff0000
    s_bitcmp1_b32 s44, 0
    s_cselect_b32 s37, s38, s37
    s_lshl_b32 s41, s44, 6
    s_waitcnt lgkmcnt(0)
    v_and_b32 v210, 0xffff0000, v201
    v_lshlrev_b32 v211, 16, v201
    v_fmac_f32 v120, s37, v210
    v_fmac_f32 v121, s37, v211
    v_and_b32 v210, 0xffff0000, v200
    v_lshlrev_b32 v211, 16, v200
    v_fmac_f32 v122, s37, v210
    v_fmac_f32 v123, s37, v211
    v_cvt_pk_bf16_f32 v208, v120, v121
    v_cvt_pk_bf16_f32 v209, v122, v123
    v_and_b32 v214, 0xffff0000, v203
    v_lshlrev_b32 v215, 16, v203
    v_fmac_f32 v124, s37, v214
    v_fmac_f32 v125, s37, v215
    v_and_b32 v214, 0xffff0000, v202
    v_lshlrev_b32 v215, 16, v202
    v_fmac_f32 v126, s37, v214
    v_fmac_f32 v127, s37, v215
    v_cvt_pk_bf16_f32 v212, v124, v125
    v_cvt_pk_bf16_f32 v213, v126, v127
    v_and_b32 v218, 0xffff0000, v205
    v_lshlrev_b32 v219, 16, v205
    v_fmac_f32 v128, s37, v218
    v_fmac_f32 v129, s37, v219
    v_and_b32 v218, 0xffff0000, v204
    v_lshlrev_b32 v219, 16, v204
    v_fmac_f32 v130, s37, v218
    v_fmac_f32 v131, s37, v219
    v_cvt_pk_bf16_f32 v216, v128, v129
    v_cvt_pk_bf16_f32 v217, v130, v131
    v_and_b32 v222, 0xffff0000, v207
    v_lshlrev_b32 v223, 16, v207
    v_fmac_f32 v132, s37, v222
    v_fmac_f32 v133, s37, v223
    v_and_b32 v222, 0xffff0000, v206
    v_lshlrev_b32 v223, 16, v206
    v_fmac_f32 v134, s37, v222
    v_fmac_f32 v135, s37, v223
    v_cvt_pk_bf16_f32 v220, v132, v133
    v_cvt_pk_bf16_f32 v221, v134, v135
    s_branch L_cend
L_set1:
    ds_read2_b32 v[44:45], v32 offset0:0 offset1:1
    ds_read2_b32 v[46:47], v32 offset0:2 offset1:3
    ds_read_b128 v[96:99], v33 offset:1024
    ds_read2_b32 v[48:49], v32 offset0:128 offset1:129
    ds_read2_b32 v[50:51], v32 offset0:130 offset1:131
    ds_read_b128 v[92:95], v33 offset:1536
    ds_read2_b32 v[52:53], v39 offset0:0 offset1:1
    ds_read2_b32 v[54:55], v39 offset0:2 offset1:3
    ds_read_b128 v[88:91], v33 offset:2048
    ds_read2_b32 v[56:57], v39 offset0:128 offset1:129
    ds_read2_b32 v[58:59], v39 offset0:130 offset1:131
    ds_read_b128 v[84:87], v33 offset:2560
    v_mov_b64 v[120:121], 0
    v_mov_b64 v[122:123], 0
    v_mov_b64 v[124:125], 0
    v_mov_b64 v[126:127], 0
    v_mov_b64 v[128:129], 0
    v_mov_b64 v[130:131], 0
    v_mov_b64 v[132:133], 0
    v_mov_b64 v[134:135], 0
    s_mov_b32 s42, 0
L_cl1:
    s_waitcnt lgkmcnt(9)
    v_mfma_f32_16x16x32_bf16 v[120:123], v[44:47], v[96:99], v[120:123]
    ds_read2_b32 v[60:61], v40 offset0:0 offset1:1
    ds_read2_b32 v[62:63], v40 offset0:2 offset1:3
    ds_read_b128 v[80:83], v33 offset:3072
    s_waitcnt lgkmcnt(9)
    v_mfma_f32_16x16x32_bf16 v[120:123], v[48:51], v[92:95], v[120:123]
    ds_read2_b32 v[64:65], v40 offset0:128 offset1:129
    ds_read2_b32 v[66:67], v40 offset0:130 offset1:131
    v_mfma_f32_16x16x32_bf16 v[124:127], v[44:47], v[92:95], v[124:127]
    ds_read_b128 v[76:79], v33 offset:3584
    s_waitcnt lgkmcnt(9)
    v_mfma_f32_16x16x32_bf16 v[120:123], v[52:55], v[88:91], v[120:123]
    ds_read2_b32 v[200:201], v32 offset0:16 offset1:17
    ds_read2_b32 v[202:203], v32 offset0:18 offset1:19
    v_mfma_f32_16x16x32_bf16 v[124:127], v[48:51], v[88:91], v[124:127]
    ds_read_b128 v[20:23], v33 offset:1088
    v_mfma_f32_16x16x32_bf16 v[128:131], v[44:47], v[88:91], v[128:131]
    s_waitcnt lgkmcnt(9)
    v_mfma_f32_16x16x32_bf16 v[120:123], v[56:59], v[84:87], v[120:123]
    ds_read2_b32 v[204:205], v32 offset0:144 offset1:145
    ds_read2_b32 v[206:207], v32 offset0:146 offset1:147
    v_mfma_f32_16x16x32_bf16 v[124:127], v[52:55], v[84:87], v[124:127]
    ds_read_b128 v[16:19], v33 offset:1600
    v_mfma_f32_16x16x32_bf16 v[128:131], v[48:51], v[84:87], v[128:131]
    v_mfma_f32_16x16x32_bf16 v[132:135], v[44:47], v[84:87], v[132:135]
    s_waitcnt lgkmcnt(9)
    v_mfma_f32_16x16x32_bf16 v[120:123], v[60:63], v[80:83], v[120:123]
    ds_read2_b32 v[208:209], v39 offset0:16 offset1:17
    ds_read2_b32 v[210:211], v39 offset0:18 offset1:19
    v_mfma_f32_16x16x32_bf16 v[124:127], v[56:59], v[80:83], v[124:127]
    ds_read_b128 v[12:15], v33 offset:2112
    v_mfma_f32_16x16x32_bf16 v[128:131], v[52:55], v[80:83], v[128:131]
    v_mfma_f32_16x16x32_bf16 v[132:135], v[48:51], v[80:83], v[132:135]
    s_waitcnt lgkmcnt(9)
    v_mfma_f32_16x16x32_bf16 v[120:123], v[64:67], v[76:79], v[120:123]
    ds_read2_b32 v[212:213], v39 offset0:144 offset1:145
    ds_read2_b32 v[214:215], v39 offset0:146 offset1:147
    v_mfma_f32_16x16x32_bf16 v[124:127], v[60:63], v[76:79], v[124:127]
    ds_read_b128 v[8:11], v33 offset:2624
    v_mfma_f32_16x16x32_bf16 v[128:131], v[56:59], v[76:79], v[128:131]
    v_mfma_f32_16x16x32_bf16 v[132:135], v[52:55], v[76:79], v[132:135]
    s_waitcnt lgkmcnt(9)
    v_mfma_f32_16x16x32_bf16 v[120:123], v[200:203], v[20:23], v[120:123]
    ds_read2_b32 v[216:217], v40 offset0:16 offset1:17
    ds_read2_b32 v[218:219], v40 offset0:18 offset1:19
    ds_read_b128 v[4:7], v33 offset:3136
    s_waitcnt lgkmcnt(9)
    v_mfma_f32_16x16x32_bf16 v[120:123], v[204:207], v[16:19], v[120:123]
    ds_read2_b32 v[220:221], v40 offset0:144 offset1:145
    ds_read2_b32 v[222:223], v40 offset0:146 offset1:147
    v_mfma_f32_16x16x32_bf16 v[124:127], v[200:203], v[16:19], v[124:127]
    ds_read_b128 v[0:3], v33 offset:3648
    s_waitcnt lgkmcnt(9)
    v_mfma_f32_16x16x32_bf16 v[120:123], v[208:211], v[12:15], v[120:123]
    ds_read2_b32 v[44:45], v32 offset0:32 offset1:33
    ds_read2_b32 v[46:47], v32 offset0:34 offset1:35
    v_mfma_f32_16x16x32_bf16 v[124:127], v[204:207], v[12:15], v[124:127]
    ds_read_b128 v[96:99], v33 offset:1152
    v_mfma_f32_16x16x32_bf16 v[128:131], v[200:203], v[12:15], v[128:131]
    s_waitcnt lgkmcnt(9)
    v_mfma_f32_16x16x32_bf16 v[120:123], v[212:215], v[8:11], v[120:123]
    ds_read2_b32 v[48:49], v32 offset0:160 offset1:161
    ds_read2_b32 v[50:51], v32 offset0:162 offset1:163
    v_mfma_f32_16x16x32_bf16 v[124:127], v[208:211], v[8:11], v[124:127]
    ds_read_b128 v[92:95], v33 offset:1664
    v_mfma_f32_16x16x32_bf16 v[128:131], v[204:207], v[8:11], v[128:131]
    v_mfma_f32_16x16x32_bf16 v[132:135], v[200:203], v[8:11], v[132:135]
    s_waitcnt lgkmcnt(9)
    v_mfma_f32_16x16x32_bf16 v[120:123], v[216:219], v[4:7], v[120:123]
    ds_read2_b32 v[52:53], v39 offset0:32 offset1:33
    ds_read2_b32 v[54:55], v39 offset0:34 offset1:35
    v_mfma_f32_16x16x32_bf16 v[124:127], v[212:215], v[4:7], v[124:127]
    ds_read_b128 v[88:91], v33 offset:2176
    v_mfma_f32_16x16x32_bf16 v[128:131], v[208:211], v[4:7], v[128:131]
    v_mfma_f32_16x16x32_bf16 v[132:135], v[204:207], v[4:7], v[132:135]
    s_waitcnt lgkmcnt(9)
    v_mfma_f32_16x16x32_bf16 v[120:123], v[220:223], v[0:3], v[120:123]
    ds_read2_b32 v[56:57], v39 offset0:160 offset1:161
    ds_read2_b32 v[58:59], v39 offset0:162 offset1:163
    v_mfma_f32_16x16x32_bf16 v[124:127], v[216:219], v[0:3], v[124:127]
    ds_read_b128 v[84:87], v33 offset:2688
    v_mfma_f32_16x16x32_bf16 v[128:131], v[212:215], v[0:3], v[128:131]
    v_mfma_f32_16x16x32_bf16 v[132:135], v[208:211], v[0:3], v[132:135]
    v_add_u32 v32, 128, v32
    v_add_u32 v33, 128, v33
    v_add_u32 v39, 128, v39
    v_add_u32 v40, 128, v40
    v_add_u32 v41, 128, v41
    s_add_u32 s42, s42, 1
    s_cmp_lt_u32 s42, 4
    s_cbranch_scc1 L_cl1
    v_sub_u32 v32, 504, v36
    v_add_u32 v32, s39, v32
    ds_read_b64 v[200:201], v32 offset:1024
    ds_read_b64 v[202:203], v32 offset:1536
    ds_read_b64 v[204:205], v32 offset:2048
    ds_read_b64 v[206:207], v32 offset:2560
    s_lshl_b32 s37, s52, 16
    s_and_b32 s38, s52, 0xffff0000
    s_bitcmp1_b32 s44, 0
    s_cselect_b32 s37, s38, s37
    s_lshl_b32 s41, s44, 6
    s_waitcnt lgkmcnt(0)
    v_and_b32 v210, 0xffff0000, v201
    v_lshlrev_b32 v211, 16, v201
    v_fmac_f32 v120, s37, v210
    v_fmac_f32 v121, s37, v211
    v_and_b32 v210, 0xffff0000, v200
    v_lshlrev_b32 v211, 16, v200
    v_fmac_f32 v122, s37, v210
    v_fmac_f32 v123, s37, v211
    v_cvt_pk_bf16_f32 v208, v120, v121
    v_cvt_pk_bf16_f32 v209, v122, v123
    v_and_b32 v214, 0xffff0000, v203
    v_lshlrev_b32 v215, 16, v203
    v_fmac_f32 v124, s37, v214
    v_fmac_f32 v125, s37, v215
    v_and_b32 v214, 0xffff0000, v202
    v_lshlrev_b32 v215, 16, v202
    v_fmac_f32 v126, s37, v214
    v_fmac_f32 v127, s37, v215
    v_cvt_pk_bf16_f32 v212, v124, v125
    v_cvt_pk_bf16_f32 v213, v126, v127
    v_and_b32 v218, 0xffff0000, v205
    v_lshlrev_b32 v219, 16, v205
    v_fmac_f32 v128, s37, v218
    v_fmac_f32 v129, s37, v219
    v_and_b32 v218, 0xffff0000, v204
    v_lshlrev_b32 v219, 16, v204
    v_fmac_f32 v130, s37, v218
    v_fmac_f32 v131, s37, v219
    v_cvt_pk_bf16_f32 v216, v128, v129
    v_cvt_pk_bf16_f32 v217, v130, v131
    v_and_b32 v222, 0xffff0000, v207
    v_lshlrev_b32 v223, 16, v207
    v_fmac_f32 v132, s37, v222
    v_fmac_f32 v133, s37, v223
    v_and_b32 v222, 0xffff0000, v206
    v_lshlrev_b32 v223, 16, v206
    v_fmac_f32 v134, s37, v222
    v_fmac_f32 v135, s37, v223
    v_cvt_pk_bf16_f32 v220, v132, v133
    v_cvt_pk_bf16_f32 v221, v134, v135
L_cend:
    v_mov_b32 v224, v34
    s_add_u32 s99, s41, 12058624
    s_cmp_ge_u32 s24, 4
    s_cbranch_scc1 L_gy0
L_e2:
    s_and_b32 s37, s24, 3
    s_mul_i32 s37, s37, 2304
    s_add_u32 s37, s37, 98304
    v_add_u32 v128, s37, v251
    v_lshl_add_u32 v129, v250, 2, s37
    v_and_b32 v130, 127, v239
    v_mov_b32 v132, 163828
    s_branch L_spE2
L_spE2_s:
    s_sleep 1
L_spE2:
    ds_read_b32 v133, v132
    s_waitcnt lgkmcnt(0)
    v_readfirstlane_b32 s30, v133
    s_cmp_lt_u32 s30, 4
    s_cbranch_scc1 L_spE2_s
    ds_read_b32 v232, v129 offset:2048
    ds_read_b32 v234, v130 offset:4096
    ds_read_b128 v[108:111], v251
    ds_read_b128 v[96:99], v128
    ds_read_b128 v[100:103], v128 offset:1024
    ds_read_b128 v[104:107], v237 offset:0
    s_waitcnt lgkmcnt(4)
    v_mfma_f32_32x32x4_2b_bf16 v[0:31], v[234:235], v[232:233], 0
    ds_read_b32 v234, v239 offset:4096
    v_mov_b64 v[64:65], 0
    v_mov_b64 v[66:67], 0
    v_mov_b64 v[68:69], 0
    v_mov_b64 v[70:71], 0
    v_mov_b64 v[72:73], 0
    v_mov_b64 v[74:75], 0
    v_mov_b64 v[76:77], 0
    v_mov_b64 v[78:79], 0
    v_mov_b64 v[80:81], 0
    v_mov_b64 v[82:83], 0
    v_mov_b64 v[84:85], 0
    v_mov_b64 v[86:87], 0
    v_mov_b64 v[88:89], 0
    v_mov_b64 v[90:91], 0
    v_mov_b64 v[92:93], 0
    v_mov_b64 v[94:95], 0
    s_waitcnt lgkmcnt(2)
    v_mfma_f32_32x32x16_bf16 v[0:15], v[108:111], v[96:99], v[0:15]
    v_mfma_f32_32x32x16_bf16 v[16:31], v[108:111], v[100:103], v[16:31]
    v_mov_b64 v[56:57], 0
    v_mov_b64 v[58:59], 0
    v_mov_b64 v[60:61], 0
    v_mov_b64 v[62:63], 0
    v_mov_b64 v[124:125], 0
    v_mov_b64 v[126:127], 0
    s_nop 5
    v_max3_f32 v128, v0, v1, v2
    v_max3_f32 v129, v16, v17, v18
    v_max3_f32 v128, v128, v3, v4
    v_max3_f32 v129, v129, v19, v20
    v_max3_f32 v128, v128, v5, v6
    v_max3_f32 v129, v129, v21, v22
    v_max3_f32 v128, v128, v7, v8
    v_max3_f32 v129, v129, v23, v24
    v_max3_f32 v128, v128, v9, v10
    v_max3_f32 v129, v129, v25, v26
    v_max3_f32 v128, v128, v11, v12
    v_max3_f32 v129, v129, v27, v28
    v_max3_f32 v128, v128, v13, v14
    v_max3_f32 v129, v129, v29, v30
    v_max_f32 v128, v128, v15
    v_max_f32 v129, v129, v31
    s_nop 1
    v_permlane32_swap_b32 v128, v129
    v_max_f32 v128, v128, v129
    v_cvt_pk_bf16_f32 v129, -v128, -v128
    v_and_b32 v130, 0xffff0000, v129
    v_sub_f32 v130, -v128, v130
    v_cvt_pk_bf16_f32 v233, -v128, v130
    s_waitcnt lgkmcnt(0)
    s_nop 0
    v_mfma_f32_32x32x4_2b_bf16 v[0:31], v[234:235], v[232:233], 0
    ds_read_b32 v234, v239 offset:4224
    ds_read_b128 v[108:111], v237 offset:1024
    s_cmp_lt_u32 s24, 4
    s_cbranch_scc1 L_e3
    s_waitcnt vmcnt(0)
    v_mov_b32 v132, 163832
    v_mov_b32 v133, 1
    s_mov_b64 exec, 1
    ds_add_u32 v132, v133
    s_mov_b64 exec, -1
    s_setprio 0
L_e3:
    s_nop 7
    v_mov_b32 v132, 163832
    s_branch L_spE3
L_spE3_s:
    s_sleep 1
L_spE3:
    ds_read_b32 v133, v132
    s_waitcnt lgkmcnt(0)
    v_readfirstlane_b32 s30, v133
    s_cmp_lt_u32 s30, 4
    s_cbranch_scc1 L_spE3_s
    v_mfma_f32_32x32x16_bf16 v[0:15], v[104:107], v[96:99], v[0:15]
    v_mfma_f32_32x32x16_bf16 v[16:31], v[104:107], v[100:103], v[16:31]
    ds_read_b64_tr_b16 v[112:113], v238 offset:4608
    ds_read_b64_tr_b16 v[114:115], v238 offset:4768
    ds_read_b64_tr_b16 v[116:117], v238 offset:5248
    ds_read_b64_tr_b16 v[118:119], v238 offset:5408
    s_nop 7
    s_cmp_ge_u32 s24, 4
    s_cbranch_scc1 L_hk1
    s_mov_b32 s37, 0
L_kvla:
    s_mov_b32 m0, s56
    s_add_u32 s56, s56, 4096
    buffer_load_dwordx4 v251, s[8:11], s57 offen sc1 lds
    s_add_u32 s57, s57, 4096
    s_cmp_ge_u32 s57, s61
    s_cselect_b32 s62, 77824, 0
    s_sub_u32 s57, s57, s62
    s_add_u32 s37, s37, 1
    s_cmp_lt_u32 s37, 9
    s_cbranch_scc1 L_kvla
L_hk1:
    v_exp_f32 v0, v0
    v_exp_f32 v1, v1
    s_waitcnt lgkmcnt(0)
    v_smfmac_f32_32x32x32_bf16 v[80:95], v[124:127], v[56:63], v236
    ds_read_b64_tr_b16 v[120:121], v238 offset:5888
    ds_read_b64_tr_b16 v[122:123], v238 offset:6048
    v_exp_f32 v2, v2
    v_exp_f32 v3, v3
    v_exp_f32 v4, v4
    v_exp_f32 v5, v5
    v_mfma_f32_32x32x4_2b_bf16 v[32:63], v[234:235], v[232:233], 0
    ds_read_b32 v234, v239 offset:13824
    v_exp_f32 v6, v6
    v_exp_f32 v7, v7
    v_exp_f32 v8, v8
    v_exp_f32 v9, v9
    v_exp_f32 v10, v10
    v_exp_f32 v11, v11
    v_exp_f32 v12, v12
    v_exp_f32 v13, v13
    v_smfmac_f32_32x32x32_bf16 v[64:79], v[112:115], v[0:7], v236
    ds_read_b64_tr_b16 v[124:125], v238 offset:6528
    ds_read_b64_tr_b16 v[126:127], v238 offset:6688
    v_exp_f32 v14, v14
    v_exp_f32 v15, v15
    v_exp_f32 v16, v16
    v_exp_f32 v17, v17
    v_smfmac_f32_32x32x32_bf16 v[64:79], v[116:119], v[8:15], v236
    ds_read_b128 v[104:107], v237 offset:9728
    v_exp_f32 v18, v18
    v_exp_f32 v19, v19
    v_exp_f32 v20, v20
    v_exp_f32 v21, v21
    v_mfma_f32_32x32x16_bf16 v[32:47], v[108:111], v[96:99], v[32:47]
    v_exp_f32 v22, v22
    v_exp_f32 v23, v23
    v_exp_f32 v24, v24
    v_exp_f32 v25, v25
    v_smfmac_f32_32x32x32_bf16 v[80:95], v[112:115], v[16:23], v236
    v_exp_f32 v26, v26
    v_exp_f32 v27, v27
    v_exp_f32 v28, v28
    v_exp_f32 v29, v29
    v_mfma_f32_32x32x16_bf16 v[48:63], v[108:111], v[100:103], v[48:63]
    v_exp_f32 v30, v30
    v_exp_f32 v31, v31
    v_exp_f32 v32, v32
    v_exp_f32 v33, v33
    s_waitcnt lgkmcnt(0)
    v_smfmac_f32_32x32x32_bf16 v[80:95], v[116:119], v[24:31], v236
    ds_read_b64_tr_b16 v[112:113], v238 offset:14336
    ds_read_b64_tr_b16 v[114:115], v238 offset:14496
    v_exp_f32 v34, v34
    v_exp_f32 v35, v35
    v_exp_f32 v36, v36
    v_exp_f32 v37, v37
    v_mfma_f32_32x32x4_2b_bf16 v[0:31], v[234:235], v[232:233], 0
    ds_read_b32 v234, v239 offset:13952
    v_exp_f32 v38, v38
    v_exp_f32 v39, v39
    v_exp_f32 v40, v40
    v_exp_f32 v41, v41
    v_exp_f32 v42, v42
    v_exp_f32 v43, v43
    v_exp_f32 v44, v44
    v_exp_f32 v45, v45
    v_smfmac_f32_32x32x32_bf16 v[64:79], v[120:123], v[32:39], v236
    ds_read_b64_tr_b16 v[116:117], v238 offset:14976
    ds_read_b64_tr_b16 v[118:119], v238 offset:15136
    v_exp_f32 v46, v46
    v_exp_f32 v47, v47
    v_exp_f32 v48, v48
    v_exp_f32 v49, v49
    v_smfmac_f32_32x32x32_bf16 v[64:79], v[124:127], v[40:47], v236
    ds_read_b128 v[108:111], v237 offset:10752
    v_exp_f32 v50, v50
    v_exp_f32 v51, v51
    v_exp_f32 v52, v52
    v_exp_f32 v53, v53
    v_mfma_f32_32x32x16_bf16 v[0:15], v[104:107], v[96:99], v[0:15]
    v_exp_f32 v54, v54
    v_exp_f32 v55, v55
    v_exp_f32 v56, v56
    v_exp_f32 v57, v57
    v_smfmac_f32_32x32x32_bf16 v[80:95], v[120:123], v[48:55], v236
    v_exp_f32 v58, v58
    v_exp_f32 v59, v59
    v_exp_f32 v60, v60
    v_exp_f32 v61, v61
    v_mfma_f32_32x32x16_bf16 v[16:31], v[104:107], v[100:103], v[16:31]
    v_exp_f32 v62, v62
    v_exp_f32 v63, v63
    s_cmp_eq_u32 s99, 0
    s_cbranch_scc1 L_hy2
    s_bitcmp1_b32 s24, 0
    s_cbranch_scc1 L_hy1
    s_add_u32 s38, s99, 2064384
    buffer_store_dwordx2 v[208:209], v224, s[8:11], s38 offen sc1
    s_add_u32 s38, s99, 1769472
    buffer_store_dwordx2 v[212:213], v224, s[8:11], s38 offen sc1
    s_add_u32 s38, s99, 294912
    buffer_store_dwordx2 v[216:217], v224, s[8:11], s38 offen sc1
    s_add_u32 s38, s99, 0
    buffer_store_dwordx2 v[220:221], v224, s[8:11], s38 offen sc1
    s_branch L_hy2
L_hy1:
    s_add_u32 s38, s99, 1474560
    buffer_store_dwordx2 v[208:209], v224, s[8:11], s38 offen sc1
    s_add_u32 s38, s99, 1179648
    buffer_store_dwordx2 v[212:213], v224, s[8:11], s38 offen sc1
    s_add_u32 s38, s99, 884736
    buffer_store_dwordx2 v[216:217], v224, s[8:11], s38 offen sc1
    s_add_u32 s38, s99, 589824
    buffer_store_dwordx2 v[220:221], v224, s[8:11], s38 offen sc1
L_hy2:
    s_cmp_lt_u32 s24, 4
    s_cbranch_scc1 L_hds
    s_cmp_eq_u32 s94, 0
    s_cbranch_scc1 L_hds
    s_add_u32 s38, s90, 4096
    buffer_store_dwordx4 v[160:163], v251, s[8:11], s90 offen offset:0 sc1
    buffer_store_dwordx4 v[164:167], v251, s[8:11], s90 offen offset:1024 sc1
    buffer_store_dwordx4 v[168:171], v251, s[8:11], s90 offen offset:2048 sc1
    buffer_store_dwordx4 v[172:175], v251, s[8:11], s90 offen offset:3072 sc1
    s_mov_b32 exec_hi, s92
    buffer_store_dwordx4 v[176:179], v251, s[8:11], s38 offen sc1
    s_mov_b32 exec_hi, -1
    s_add_u32 s90, s90, s91
    s_add_u32 s38, s90, 4096
    buffer_store_dwordx4 v[180:183], v251, s[8:11], s90 offen offset:0 sc1
    buffer_store_dwordx4 v[184:187], v251, s[8:11], s90 offen offset:1024 sc1
    buffer_store_dwordx4 v[188:191], v251, s[8:11], s90 offen offset:2048 sc1
    buffer_store_dwordx4 v[192:195], v251, s[8:11], s90 offen offset:3072 sc1
    s_mov_b32 exec_hi, s92
    buffer_store_dwordx4 v[196:199], v251, s[8:11], s38 offen sc1
    s_mov_b32 exec_hi, -1
    s_add_u32 s90, s90, s91
L_hds:
    v_exp_f32 v0, v0
    v_exp_f32 v1, v1
    s_waitcnt lgkmcnt(0)
    v_smfmac_f32_32x32x32_bf16 v[80:95], v[124:127], v[56:63], v236
    ds_read_b64_tr_b16 v[120:121], v238 offset:15616
    ds_read_b64_tr_b16 v[122:123], v238 offset:15776
    v_exp_f32 v2, v2
    v_exp_f32 v3, v3
    v_exp_f32 v4, v4
    v_exp_f32 v5, v5
    v_mfma_f32_32x32x4_2b_bf16 v[32:63], v[234:235], v[232:233], 0
    ds_read_b32 v234, v239 offset:23552
    v_exp_f32 v6, v6
    v_exp_f32 v7, v7
    v_exp_f32 v8, v8
    v_exp_f32 v9, v9
    v_exp_f32 v10, v10
    v_exp_f32 v11, v11
    v_exp_f32 v12, v12
    v_exp_f32 v13, v13
    v_smfmac_f32_32x32x32_bf16 v[64:79], v[112:115], v[0:7], v236
    ds_read_b64_tr_b16 v[124:125], v238 offset:16256
    ds_read_b64_tr_b16 v[126:127], v238 offset:16416
    v_exp_f32 v14, v14
    v_exp_f32 v15, v15
    v_exp_f32 v16, v16
    v_exp_f32 v17, v17
    v_smfmac_f32_32x32x32_bf16 v[64:79], v[116:119], v[8:15], v236
    ds_read_b128 v[104:107], v237 offset:19456
    v_exp_f32 v18, v18
    v_exp_f32 v19, v19
    v_exp_f32 v20, v20
    v_exp_f32 v21, v21
    v_mfma_f32_32x32x16_bf16 v[32:47], v[108:111], v[96:99], v[32:47]
    v_exp_f32 v22, v22
    v_exp_f32 v23, v23
    v_exp_f32 v24, v24
    v_exp_f32 v25, v25
    v_smfmac_f32_32x32x32_bf16 v[80:95], v[112:115], v[16:23], v236
    v_exp_f32 v26, v26
    v_exp_f32 v27, v27
    v_exp_f32 v28, v28
    v_exp_f32 v29, v29
    v_mfma_f32_32x32x16_bf16 v[48:63], v[108:111], v[100:103], v[48:63]
    v_exp_f32 v30, v30
    v_exp_f32 v31, v31
    v_exp_f32 v32, v32
    v_exp_f32 v33, v33
    s_waitcnt lgkmcnt(0)
    v_smfmac_f32_32x32x32_bf16 v[80:95], v[116:119], v[24:31], v236
    ds_read_b64_tr_b16 v[112:113], v238 offset:24064
    ds_read_b64_tr_b16 v[114:115], v238 offset:24224
    v_exp_f32 v34, v34
    v_exp_f32 v35, v35
    v_exp_f32 v36, v36
    v_exp_f32 v37, v37
    v_mfma_f32_32x32x4_2b_bf16 v[0:31], v[234:235], v[232:233], 0
    ds_read_b32 v234, v239 offset:23680
    v_exp_f32 v38, v38
    v_exp_f32 v39, v39
    v_exp_f32 v40, v40
    v_exp_f32 v41, v41
    v_exp_f32 v42, v42
    v_exp_f32 v43, v43
    v_exp_f32 v44, v44
    v_exp_f32 v45, v45
    v_smfmac_f32_32x32x32_bf16 v[64:79], v[120:123], v[32:39], v236
    ds_read_b64_tr_b16 v[116:117], v238 offset:24704
    ds_read_b64_tr_b16 v[118:119], v238 offset:24864
    v_exp_f32 v46, v46
    v_exp_f32 v47, v47
    v_exp_f32 v48, v48
    v_exp_f32 v49, v49
    v_smfmac_f32_32x32x32_bf16 v[64:79], v[124:127], v[40:47], v236
    ds_read_b128 v[108:111], v237 offset:20480
    v_exp_f32 v50, v50
    v_exp_f32 v51, v51
    v_exp_f32 v52, v52
    v_exp_f32 v53, v53
    v_mfma_f32_32x32x16_bf16 v[0:15], v[104:107], v[96:99], v[0:15]
    v_exp_f32 v54, v54
    v_exp_f32 v55, v55
    v_exp_f32 v56, v56
    v_exp_f32 v57, v57
    v_smfmac_f32_32x32x32_bf16 v[80:95], v[120:123], v[48:55], v236
    v_exp_f32 v58, v58
    v_exp_f32 v59, v59
    v_exp_f32 v60, v60
    v_exp_f32 v61, v61
    v_mfma_f32_32x32x16_bf16 v[16:31], v[104:107], v[100:103], v[16:31]
    v_exp_f32 v62, v62
    v_exp_f32 v63, v63
    v_exp_f32 v0, v0
    v_exp_f32 v1, v1
    s_waitcnt lgkmcnt(0)
    v_smfmac_f32_32x32x32_bf16 v[80:95], v[124:127], v[56:63], v236
    ds_read_b64_tr_b16 v[120:121], v238 offset:25344
    ds_read_b64_tr_b16 v[122:123], v238 offset:25504
    v_exp_f32 v2, v2
    v_exp_f32 v3, v3
    v_exp_f32 v4, v4
    v_exp_f32 v5, v5
    v_mfma_f32_32x32x4_2b_bf16 v[32:63], v[234:235], v[232:233], 0
    ds_read_b32 v234, v239 offset:33280
    v_exp_f32 v6, v6
    v_exp_f32 v7, v7
    v_exp_f32 v8, v8
    v_exp_f32 v9, v9
    v_exp_f32 v10, v10
    v_exp_f32 v11, v11
    v_exp_f32 v12, v12
    v_exp_f32 v13, v13
    v_smfmac_f32_32x32x32_bf16 v[64:79], v[112:115], v[0:7], v236
    ds_read_b64_tr_b16 v[124:125], v238 offset:25984
    ds_read_b64_tr_b16 v[126:127], v238 offset:26144
    v_exp_f32 v14, v14
    v_exp_f32 v15, v15
    v_exp_f32 v16, v16
    v_exp_f32 v17, v17
    v_smfmac_f32_32x32x32_bf16 v[64:79], v[116:119], v[8:15], v236
    ds_read_b128 v[104:107], v237 offset:29184
    v_exp_f32 v18, v18
    v_exp_f32 v19, v19
    v_exp_f32 v20, v20
    v_exp_f32 v21, v21
    v_mfma_f32_32x32x16_bf16 v[32:47], v[108:111], v[96:99], v[32:47]
    v_exp_f32 v22, v22
    v_exp_f32 v23, v23
    v_exp_f32 v24, v24
    v_exp_f32 v25, v25
    v_smfmac_f32_32x32x32_bf16 v[80:95], v[112:115], v[16:23], v236
    v_exp_f32 v26, v26
    v_exp_f32 v27, v27
    v_exp_f32 v28, v28
    v_exp_f32 v29, v29
    v_mfma_f32_32x32x16_bf16 v[48:63], v[108:111], v[100:103], v[48:63]
    v_exp_f32 v30, v30
    v_exp_f32 v31, v31
    v_exp_f32 v32, v32
    v_exp_f32 v33, v33
    s_waitcnt lgkmcnt(0)
    v_smfmac_f32_32x32x32_bf16 v[80:95], v[116:119], v[24:31], v236
    ds_read_b64_tr_b16 v[112:113], v238 offset:33792
    ds_read_b64_tr_b16 v[114:115], v238 offset:33952
    v_exp_f32 v34, v34
    v_exp_f32 v35, v35
    v_exp_f32 v36, v36
    v_exp_f32 v37, v37
    v_mfma_f32_32x32x4_2b_bf16 v[0:31], v[234:235], v[232:233], 0
    ds_read_b32 v234, v239 offset:33408
    v_exp_f32 v38, v38
    v_exp_f32 v39, v39
    v_exp_f32 v40, v40
    v_exp_f32 v41, v41
    v_exp_f32 v42, v42
    v_exp_f32 v43, v43
    v_exp_f32 v44, v44
    v_exp_f32 v45, v45
    v_smfmac_f32_32x32x32_bf16 v[64:79], v[120:123], v[32:39], v236
    ds_read_b64_tr_b16 v[116:117], v238 offset:34432
    ds_read_b64_tr_b16 v[118:119], v238 offset:34592
    v_exp_f32 v46, v46
    v_exp_f32 v47, v47
    v_exp_f32 v48, v48
    v_exp_f32 v49, v49
    v_smfmac_f32_32x32x32_bf16 v[64:79], v[124:127], v[40:47], v236
    ds_read_b128 v[108:111], v237 offset:30208
    v_exp_f32 v50, v50
    v_exp_f32 v51, v51
    v_exp_f32 v52, v52
    v_exp_f32 v53, v53
    v_mfma_f32_32x32x16_bf16 v[0:15], v[104:107], v[96:99], v[0:15]
    v_exp_f32 v54, v54
    v_exp_f32 v55, v55
    v_exp_f32 v56, v56
    v_exp_f32 v57, v57
    v_smfmac_f32_32x32x32_bf16 v[80:95], v[120:123], v[48:55], v236
    v_exp_f32 v58, v58
    v_exp_f32 v59, v59
    v_exp_f32 v60, v60
    v_exp_f32 v61, v61
    v_mfma_f32_32x32x16_bf16 v[16:31], v[104:107], v[100:103], v[16:31]
    v_exp_f32 v62, v62
    v_exp_f32 v63, v63
    s_waitcnt vmcnt(0)
    s_barrier
    s_cmp_lg_u32 s24, 3
    s_cbranch_scc1 L_hk2
    s_lshl_b32 s26, s2, 7
    s_add_u32 s26, s26, 14516224
    v_mov_b32 v253, s25
    s_mov_b64 exec, 1
    buffer_store_dword v253, v251, s[8:11], s26 offen sc1
    s_mov_b64 exec, -1
L_hk2:
    s_cmp_lg_u32 s24, 4
    s_cbranch_scc1 L_hd
    s_cmp_eq_u32 s94, 0
    s_cbranch_scc1 L_hd
    s_lshl_b32 s26, s93, 7
    s_add_u32 s26, s26, 14417920
    v_mov_b32 v253, s25
    s_mov_b64 exec, 1
    buffer_store_dword v253, v251, s[8:11], s26 offen sc1
    s_mov_b64 exec, -1
L_hd:
    v_exp_f32 v0, v0
    v_exp_f32 v1, v1
    s_waitcnt lgkmcnt(0)
    v_smfmac_f32_32x32x32_bf16 v[80:95], v[124:127], v[56:63], v236
    ds_read_b64_tr_b16 v[120:121], v238 offset:35072
    ds_read_b64_tr_b16 v[122:123], v238 offset:35232
    v_exp_f32 v2, v2
    v_exp_f32 v3, v3
    v_exp_f32 v4, v4
    v_exp_f32 v5, v5
    v_mfma_f32_32x32x4_2b_bf16 v[32:63], v[234:235], v[232:233], 0
    ds_read_b32 v234, v239 offset:43008
    v_exp_f32 v6, v6
    v_exp_f32 v7, v7
    v_exp_f32 v8, v8
    v_exp_f32 v9, v9
    v_exp_f32 v10, v10
    v_exp_f32 v11, v11
    v_exp_f32 v12, v12
    v_exp_f32 v13, v13
    v_smfmac_f32_32x32x32_bf16 v[64:79], v[112:115], v[0:7], v236
    ds_read_b64_tr_b16 v[124:125], v238 offset:35712
    ds_read_b64_tr_b16 v[126:127], v238 offset:35872
    v_exp_f32 v14, v14
    v_exp_f32 v15, v15
    v_exp_f32 v16, v16
    v_exp_f32 v17, v17
    v_smfmac_f32_32x32x32_bf16 v[64:79], v[116:119], v[8:15], v236
    ds_read_b128 v[104:107], v237 offset:38912
    v_exp_f32 v18, v18
    v_exp_f32 v19, v19
    v_exp_f32 v20, v20
    v_exp_f32 v21, v21
    v_mfma_f32_32x32x16_bf16 v[32:47], v[108:111], v[96:99], v[32:47]
    v_exp_f32 v22, v22
    v_exp_f32 v23, v23
    v_exp_f32 v24, v24
    v_exp_f32 v25, v25
    v_smfmac_f32_32x32x32_bf16 v[80:95], v[112:115], v[16:23], v236
    v_exp_f32 v26, v26
    v_exp_f32 v27, v27
    v_exp_f32 v28, v28
    v_exp_f32 v29, v29
    v_mfma_f32_32x32x16_bf16 v[48:63], v[108:111], v[100:103], v[48:63]
    v_exp_f32 v30, v30
    v_exp_f32 v31, v31
    v_exp_f32 v32, v32
    v_exp_f32 v33, v33
    s_waitcnt lgkmcnt(0)
    v_smfmac_f32_32x32x32_bf16 v[80:95], v[116:119], v[24:31], v236
    ds_read_b64_tr_b16 v[112:113], v238 offset:43520
    ds_read_b64_tr_b16 v[114:115], v238 offset:43680
    v_exp_f32 v34, v34
    v_exp_f32 v35, v35
    v_exp_f32 v36, v36
    v_exp_f32 v37, v37
    v_mfma_f32_32x32x4_2b_bf16 v[0:31], v[234:235], v[232:233], 0
    ds_read_b32 v234, v239 offset:43136
    v_exp_f32 v38, v38
    v_exp_f32 v39, v39
    v_exp_f32 v40, v40
    v_exp_f32 v41, v41
    v_exp_f32 v42, v42
    v_exp_f32 v43, v43
    v_exp_f32 v44, v44
    v_exp_f32 v45, v45
    v_smfmac_f32_32x32x32_bf16 v[64:79], v[120:123], v[32:39], v236
    ds_read_b64_tr_b16 v[116:117], v238 offset:44160
    ds_read_b64_tr_b16 v[118:119], v238 offset:44320
    v_exp_f32 v46, v46
    v_exp_f32 v47, v47
    v_exp_f32 v48, v48
    v_exp_f32 v49, v49
    v_smfmac_f32_32x32x32_bf16 v[64:79], v[124:127], v[40:47], v236
    ds_read_b128 v[108:111], v237 offset:39936
    v_exp_f32 v50, v50
    v_exp_f32 v51, v51
    v_exp_f32 v52, v52
    v_exp_f32 v53, v53
    v_mfma_f32_32x32x16_bf16 v[0:15], v[104:107], v[96:99], v[0:15]
    v_exp_f32 v54, v54
    v_exp_f32 v55, v55
    v_exp_f32 v56, v56
    v_exp_f32 v57, v57
    v_smfmac_f32_32x32x32_bf16 v[80:95], v[120:123], v[48:55], v236
    v_exp_f32 v58, v58
    v_exp_f32 v59, v59
    v_exp_f32 v60, v60
    v_exp_f32 v61, v61
    v_mfma_f32_32x32x16_bf16 v[16:31], v[104:107], v[100:103], v[16:31]
    v_exp_f32 v62, v62
    v_exp_f32 v63, v63
    v_add_u32 v237, 38912, v237
    v_add_u32 v238, 38912, v238
    v_add_u32 v239, 38912, v239
    v_exp_f32 v0, v0
    v_exp_f32 v1, v1
    s_waitcnt lgkmcnt(0)
    v_smfmac_f32_32x32x32_bf16 v[80:95], v[124:127], v[56:63], v236
    ds_read_b64_tr_b16 v[120:121], v238 offset:5888
    ds_read_b64_tr_b16 v[122:123], v238 offset:6048
    v_exp_f32 v2, v2
    v_exp_f32 v3, v3
    v_exp_f32 v4, v4
    v_exp_f32 v5, v5
    v_mfma_f32_32x32x4_2b_bf16 v[32:63], v[234:235], v[232:233], 0
    ds_read_b32 v234, v239 offset:13824
    v_exp_f32 v6, v6
    v_exp_f32 v7, v7
    v_exp_f32 v8, v8
    v_exp_f32 v9, v9
    v_exp_f32 v10, v10
    v_exp_f32 v11, v11
    v_exp_f32 v12, v12
    v_exp_f32 v13, v13
    v_smfmac_f32_32x32x32_bf16 v[64:79], v[112:115], v[0:7], v236
    ds_read_b64_tr_b16 v[124:125], v238 offset:6528
    ds_read_b64_tr_b16 v[126:127], v238 offset:6688
    v_exp_f32 v14, v14
    v_exp_f32 v15, v15
    v_exp_f32 v16, v16
    v_exp_f32 v17, v17
    v_smfmac_f32_32x32x32_bf16 v[64:79], v[116:119], v[8:15], v236
    ds_read_b128 v[104:107], v237 offset:9728
    v_exp_f32 v18, v18
    v_exp_f32 v19, v19
    v_exp_f32 v20, v20
    v_exp_f32 v21, v21
    v_mfma_f32_32x32x16_bf16 v[32:47], v[108:111], v[96:99], v[32:47]
    v_exp_f32 v22, v22
    v_exp_f32 v23, v23
    v_exp_f32 v24, v24
    v_exp_f32 v25, v25
    v_smfmac_f32_32x32x32_bf16 v[80:95], v[112:115], v[16:23], v236
    v_exp_f32 v26, v26
    v_exp_f32 v27, v27
    v_exp_f32 v28, v28
    v_exp_f32 v29, v29
    v_mfma_f32_32x32x16_bf16 v[48:63], v[108:111], v[100:103], v[48:63]
    v_exp_f32 v30, v30
    v_exp_f32 v31, v31
    v_exp_f32 v32, v32
    v_exp_f32 v33, v33
    s_waitcnt lgkmcnt(0)
    v_smfmac_f32_32x32x32_bf16 v[80:95], v[116:119], v[24:31], v236
    ds_read_b64_tr_b16 v[112:113], v238 offset:14336
    ds_read_b64_tr_b16 v[114:115], v238 offset:14496
    v_exp_f32 v34, v34
    v_exp_f32 v35, v35
    v_exp_f32 v36, v36
    v_exp_f32 v37, v37
    v_mfma_f32_32x32x4_2b_bf16 v[0:31], v[234:235], v[232:233], 0
    ds_read_b32 v234, v239 offset:13952
    v_exp_f32 v38, v38
    v_exp_f32 v39, v39
    v_exp_f32 v40, v40
    v_exp_f32 v41, v41
    v_exp_f32 v42, v42
    v_exp_f32 v43, v43
    v_exp_f32 v44, v44
    v_exp_f32 v45, v45
    v_smfmac_f32_32x32x32_bf16 v[64:79], v[120:123], v[32:39], v236
    ds_read_b64_tr_b16 v[116:117], v238 offset:14976
    ds_read_b64_tr_b16 v[118:119], v238 offset:15136
    v_exp_f32 v46, v46
    v_exp_f32 v47, v47
    v_exp_f32 v48, v48
    v_exp_f32 v49, v49
    v_smfmac_f32_32x32x32_bf16 v[64:79], v[124:127], v[40:47], v236
    ds_read_b128 v[108:111], v237 offset:10752
    v_exp_f32 v50, v50
    v_exp_f32 v51, v51
    v_exp_f32 v52, v52
    v_exp_f32 v53, v53
    v_mfma_f32_32x32x16_bf16 v[0:15], v[104:107], v[96:99], v[0:15]
    v_exp_f32 v54, v54
    v_exp_f32 v55, v55
    v_exp_f32 v56, v56
    v_exp_f32 v57, v57
    v_smfmac_f32_32x32x32_bf16 v[80:95], v[120:123], v[48:55], v236
    v_exp_f32 v58, v58
    v_exp_f32 v59, v59
    v_exp_f32 v60, v60
    v_exp_f32 v61, v61
    v_mfma_f32_32x32x16_bf16 v[16:31], v[104:107], v[100:103], v[16:31]
    v_exp_f32 v62, v62
    v_exp_f32 v63, v63
    s_cmp_ge_u32 s24, 4
    s_cbranch_scc1 L_hk3
    s_lshr_b32 s37, s31, 3
    s_lshl_b32 s37, s37, 11
    s_add_u32 s46, s37, 14427136
    v_and_b32 v142, 7, v250
    v_and_b32 v143, 8, v250
    v_lshlrev_b32 v142, 7, v142
    v_lshl_add_u32 v142, v143, 10, v142
    s_mov_b32 s30, 0
L_s1b_poll:
    buffer_load_dword v143, v142, s[8:11], s46 offen sc1
    s_waitcnt vmcnt(0)
    v_xor_b32 v143, s25, v143
    v_cmp_ne_u32 vcc, 0, v143
    s_add_u32 s30, s30, 1
    s_cmp_gt_u32 s30, 65536
    s_cbranch_scc1 L_s1b_pdone
    s_cmp_eq_u64 vcc, 0
    s_cbranch_scc1 L_s1b_pdone
    s_sleep 2
    s_branch L_s1b_poll
L_s1b_pdone:
    s_add_u32 s57, s57, 77824
    s_add_u32 s61, s61, 77824
    s_mov_b32 s37, 0
L_kvlb:
    s_mov_b32 m0, s56
    s_add_u32 s56, s56, 4096
    buffer_load_dwordx4 v251, s[8:11], s57 offen sc1 lds
    s_add_u32 s57, s57, 4096
    s_cmp_ge_u32 s57, s61
    s_cselect_b32 s62, 77824, 0
    s_sub_u32 s57, s57, s62
    s_add_u32 s37, s37, 1
    s_cmp_lt_u32 s37, 19
    s_cbranch_scc1 L_kvlb
L_hk3:
    v_exp_f32 v0, v0
    v_exp_f32 v1, v1
    s_waitcnt lgkmcnt(0)
    v_smfmac_f32_32x32x32_bf16 v[80:95], v[124:127], v[56:63], v236
    ds_read_b64_tr_b16 v[120:121], v238 offset:15616
    ds_read_b64_tr_b16 v[122:123], v238 offset:15776
    v_exp_f32 v2, v2
    v_exp_f32 v3, v3
    v_exp_f32 v4, v4
    v_exp_f32 v5, v5
    v_mfma_f32_32x32x4_2b_bf16 v[32:63], v[234:235], v[232:233], 0
    ds_read_b32 v234, v239 offset:23552
    v_exp_f32 v6, v6
    v_exp_f32 v7, v7
    v_exp_f32 v8, v8
    v_exp_f32 v9, v9
    v_exp_f32 v10, v10
    v_exp_f32 v11, v11
    v_exp_f32 v12, v12
    v_exp_f32 v13, v13
    v_smfmac_f32_32x32x32_bf16 v[64:79], v[112:115], v[0:7], v236
    ds_read_b64_tr_b16 v[124:125], v238 offset:16256
    ds_read_b64_tr_b16 v[126:127], v238 offset:16416
    v_exp_f32 v14, v14
    v_exp_f32 v15, v15
    v_exp_f32 v16, v16
    v_exp_f32 v17, v17
    v_smfmac_f32_32x32x32_bf16 v[64:79], v[116:119], v[8:15], v236
    ds_read_b128 v[104:107], v237 offset:19456
    v_exp_f32 v18, v18
    v_exp_f32 v19, v19
    v_exp_f32 v20, v20
    v_exp_f32 v21, v21
    v_mfma_f32_32x32x16_bf16 v[32:47], v[108:111], v[96:99], v[32:47]
    v_exp_f32 v22, v22
    v_exp_f32 v23, v23
    v_exp_f32 v24, v24
    v_exp_f32 v25, v25
    v_smfmac_f32_32x32x32_bf16 v[80:95], v[112:115], v[16:23], v236
    v_exp_f32 v26, v26
    v_exp_f32 v27, v27
    v_exp_f32 v28, v28
    v_exp_f32 v29, v29
    v_mfma_f32_32x32x16_bf16 v[48:63], v[108:111], v[100:103], v[48:63]
    v_exp_f32 v30, v30
    v_exp_f32 v31, v31
    v_exp_f32 v32, v32
    v_exp_f32 v33, v33
    s_waitcnt lgkmcnt(0)
    v_smfmac_f32_32x32x32_bf16 v[80:95], v[116:119], v[24:31], v236
    ds_read_b64_tr_b16 v[112:113], v238 offset:24064
    ds_read_b64_tr_b16 v[114:115], v238 offset:24224
    v_exp_f32 v34, v34
    v_exp_f32 v35, v35
    v_exp_f32 v36, v36
    v_exp_f32 v37, v37
    v_mfma_f32_32x32x4_2b_bf16 v[0:31], v[234:235], v[232:233], 0
    ds_read_b32 v234, v239 offset:23680
    v_exp_f32 v38, v38
    v_exp_f32 v39, v39
    v_exp_f32 v40, v40
    v_exp_f32 v41, v41
    v_exp_f32 v42, v42
    v_exp_f32 v43, v43
    v_exp_f32 v44, v44
    v_exp_f32 v45, v45
    v_smfmac_f32_32x32x32_bf16 v[64:79], v[120:123], v[32:39], v236
    ds_read_b64_tr_b16 v[116:117], v238 offset:24704
    ds_read_b64_tr_b16 v[118:119], v238 offset:24864
    v_exp_f32 v46, v46
    v_exp_f32 v47, v47
    v_exp_f32 v48, v48
    v_exp_f32 v49, v49
    v_smfmac_f32_32x32x32_bf16 v[64:79], v[124:127], v[40:47], v236
    ds_read_b128 v[108:111], v237 offset:20480
    v_exp_f32 v50, v50
    v_exp_f32 v51, v51
    v_exp_f32 v52, v52
    v_exp_f32 v53, v53
    v_mfma_f32_32x32x16_bf16 v[0:15], v[104:107], v[96:99], v[0:15]
    v_exp_f32 v54, v54
    v_exp_f32 v55, v55
    v_exp_f32 v56, v56
    v_exp_f32 v57, v57
    v_smfmac_f32_32x32x32_bf16 v[80:95], v[120:123], v[48:55], v236
    v_exp_f32 v58, v58
    v_exp_f32 v59, v59
    v_exp_f32 v60, v60
    v_exp_f32 v61, v61
    v_mfma_f32_32x32x16_bf16 v[16:31], v[104:107], v[100:103], v[16:31]
    v_exp_f32 v62, v62
    v_exp_f32 v63, v63
    v_exp_f32 v0, v0
    v_exp_f32 v1, v1
    s_waitcnt lgkmcnt(0)
    v_smfmac_f32_32x32x32_bf16 v[80:95], v[124:127], v[56:63], v236
    ds_read_b64_tr_b16 v[120:121], v238 offset:25344
    ds_read_b64_tr_b16 v[122:123], v238 offset:25504
    v_exp_f32 v2, v2
    v_exp_f32 v3, v3
    v_exp_f32 v4, v4
    v_exp_f32 v5, v5
    v_mfma_f32_32x32x4_2b_bf16 v[32:63], v[234:235], v[232:233], 0
    ds_read_b32 v234, v239 offset:33280
    v_exp_f32 v6, v6
    v_exp_f32 v7, v7
    v_exp_f32 v8, v8
    v_exp_f32 v9, v9
    v_exp_f32 v10, v10
    v_exp_f32 v11, v11
    v_exp_f32 v12, v12
    v_exp_f32 v13, v13
    v_smfmac_f32_32x32x32_bf16 v[64:79], v[112:115], v[0:7], v236
    ds_read_b64_tr_b16 v[124:125], v238 offset:25984
    ds_read_b64_tr_b16 v[126:127], v238 offset:26144
    v_exp_f32 v14, v14
    v_exp_f32 v15, v15
    v_exp_f32 v16, v16
    v_exp_f32 v17, v17
    v_smfmac_f32_32x32x32_bf16 v[64:79], v[116:119], v[8:15], v236
    ds_read_b128 v[104:107], v237 offset:29184
    v_exp_f32 v18, v18
    v_exp_f32 v19, v19
    v_exp_f32 v20, v20
    v_exp_f32 v21, v21
    v_mfma_f32_32x32x16_bf16 v[32:47], v[108:111], v[96:99], v[32:47]
    v_exp_f32 v22, v22
    v_exp_f32 v23, v23
    v_exp_f32 v24, v24
    v_exp_f32 v25, v25
    v_smfmac_f32_32x32x32_bf16 v[80:95], v[112:115], v[16:23], v236
    v_exp_f32 v26, v26
    v_exp_f32 v27, v27
    v_exp_f32 v28, v28
    v_exp_f32 v29, v29
    v_mfma_f32_32x32x16_bf16 v[48:63], v[108:111], v[100:103], v[48:63]
    v_exp_f32 v30, v30
    v_exp_f32 v31, v31
    v_exp_f32 v32, v32
    v_exp_f32 v33, v33
    s_waitcnt lgkmcnt(0)
    v_smfmac_f32_32x32x32_bf16 v[80:95], v[116:119], v[24:31], v236
    ds_read_b64_tr_b16 v[112:113], v238 offset:33792
    ds_read_b64_tr_b16 v[114:115], v238 offset:33952
    v_exp_f32 v34, v34
    v_exp_f32 v35, v35
    v_exp_f32 v36, v36
    v_exp_f32 v37, v37
    v_mfma_f32_32x32x4_2b_bf16 v[0:31], v[234:235], v[232:233], 0
    ds_read_b32 v234, v239 offset:33408
    v_exp_f32 v38, v38
    v_exp_f32 v39, v39
    v_exp_f32 v40, v40
    v_exp_f32 v41, v41
    v_exp_f32 v42, v42
    v_exp_f32 v43, v43
    v_exp_f32 v44, v44
    v_exp_f32 v45, v45
    v_smfmac_f32_32x32x32_bf16 v[64:79], v[120:123], v[32:39], v236
    ds_read_b64_tr_b16 v[116:117], v238 offset:34432
    ds_read_b64_tr_b16 v[118:119], v238 offset:34592
    v_exp_f32 v46, v46
    v_exp_f32 v47, v47
    v_exp_f32 v48, v48
    v_exp_f32 v49, v49
    v_smfmac_f32_32x32x32_bf16 v[64:79], v[124:127], v[40:47], v236
    ds_read_b128 v[108:111], v237 offset:30208
    v_exp_f32 v50, v50
    v_exp_f32 v51, v51
    v_exp_f32 v52, v52
    v_exp_f32 v53, v53
    v_mfma_f32_32x32x16_bf16 v[0:15], v[104:107], v[96:99], v[0:15]
    v_exp_f32 v54, v54
    v_exp_f32 v55, v55
    v_exp_f32 v56, v56
    v_exp_f32 v57, v57
    v_smfmac_f32_32x32x32_bf16 v[80:95], v[120:123], v[48:55], v236
    v_exp_f32 v58, v58
    v_exp_f32 v59, v59
    v_exp_f32 v60, v60
    v_exp_f32 v61, v61
    v_mfma_f32_32x32x16_bf16 v[16:31], v[104:107], v[100:103], v[16:31]
    v_exp_f32 v62, v62
    v_exp_f32 v63, v63
    s_waitcnt vmcnt(0)
    s_barrier
    s_mov_b64 s[12:13], s[68:69]
    s_mov_b32 s14, 663552
    s_mov_b32 s15, 0x20000
    s_cmp_ge_u32 s24, 4
    s_cbranch_scc1 L_pf0
    s_lshr_b32 s40, s2, 3
    s_mul_i32 s41, s40, 43
    s_lshr_b32 s41, s41, 8
    s_mul_i32 s41, s41, 6
    s_sub_u32 s41, s40, s41
    s_mul_i32 s41, s41, 192
    s_and_b32 s41, s41, 0xffffff80
    s_cmp_ge_u32 s40, 24
    s_cselect_b32 s41, 0x40000000, s41
    v_mul_u32_u24 v141, 1152, v252
    buffer_load_dword v140, v141, s[12:15], s41 offen offset:0
L_pf0:
    v_exp_f32 v0, v0
    v_exp_f32 v1, v1
    s_waitcnt lgkmcnt(0)
    v_smfmac_f32_32x32x32_bf16 v[80:95], v[124:127], v[56:63], v236
    ds_read_b64_tr_b16 v[120:121], v238 offset:35072
    ds_read_b64_tr_b16 v[122:123], v238 offset:35232
    v_exp_f32 v2, v2
    v_exp_f32 v3, v3
    v_exp_f32 v4, v4
    v_exp_f32 v5, v5
    v_mfma_f32_32x32x4_2b_bf16 v[32:63], v[234:235], v[232:233], 0
    ds_read_b32 v234, v239 offset:43008
    v_exp_f32 v6, v6
    v_exp_f32 v7, v7
    v_exp_f32 v8, v8
    v_exp_f32 v9, v9
    v_exp_f32 v10, v10
    v_exp_f32 v11, v11
    v_exp_f32 v12, v12
    v_exp_f32 v13, v13
    v_smfmac_f32_32x32x32_bf16 v[64:79], v[112:115], v[0:7], v236
    ds_read_b64_tr_b16 v[124:125], v238 offset:35712
    ds_read_b64_tr_b16 v[126:127], v238 offset:35872
    v_exp_f32 v14, v14
    v_exp_f32 v15, v15
    v_exp_f32 v16, v16
    v_exp_f32 v17, v17
    v_smfmac_f32_32x32x32_bf16 v[64:79], v[116:119], v[8:15], v236
    ds_read_b128 v[104:107], v237 offset:38912
    v_exp_f32 v18, v18
    v_exp_f32 v19, v19
    v_exp_f32 v20, v20
    v_exp_f32 v21, v21
    v_mfma_f32_32x32x16_bf16 v[32:47], v[108:111], v[96:99], v[32:47]
    v_exp_f32 v22, v22
    v_exp_f32 v23, v23
    v_exp_f32 v24, v24
    v_exp_f32 v25, v25
    v_smfmac_f32_32x32x32_bf16 v[80:95], v[112:115], v[16:23], v236
    v_exp_f32 v26, v26
    v_exp_f32 v27, v27
    v_exp_f32 v28, v28
    v_exp_f32 v29, v29
    v_mfma_f32_32x32x16_bf16 v[48:63], v[108:111], v[100:103], v[48:63]
    v_exp_f32 v30, v30
    v_exp_f32 v31, v31
    v_exp_f32 v32, v32
    v_exp_f32 v33, v33
    s_waitcnt lgkmcnt(0)
    v_smfmac_f32_32x32x32_bf16 v[80:95], v[116:119], v[24:31], v236
    ds_read_b64_tr_b16 v[112:113], v238 offset:43520
    ds_read_b64_tr_b16 v[114:115], v238 offset:43680
    v_exp_f32 v34, v34
    v_exp_f32 v35, v35
    v_exp_f32 v36, v36
    v_exp_f32 v37, v37
    v_mfma_f32_32x32x4_2b_bf16 v[0:31], v[234:235], v[232:233], 0
    ds_read_b32 v234, v239 offset:43136
    v_exp_f32 v38, v38
    v_exp_f32 v39, v39
    v_exp_f32 v40, v40
    v_exp_f32 v41, v41
    v_exp_f32 v42, v42
    v_exp_f32 v43, v43
    v_exp_f32 v44, v44
    v_exp_f32 v45, v45
    v_smfmac_f32_32x32x32_bf16 v[64:79], v[120:123], v[32:39], v236
    ds_read_b64_tr_b16 v[116:117], v238 offset:44160
    ds_read_b64_tr_b16 v[118:119], v238 offset:44320
    v_exp_f32 v46, v46
    v_exp_f32 v47, v47
    v_exp_f32 v48, v48
    v_exp_f32 v49, v49
    v_smfmac_f32_32x32x32_bf16 v[64:79], v[124:127], v[40:47], v236
    ds_read_b128 v[108:111], v237 offset:39936
    v_exp_f32 v50, v50
    v_exp_f32 v51, v51
    v_exp_f32 v52, v52
    v_exp_f32 v53, v53
    v_mfma_f32_32x32x16_bf16 v[0:15], v[104:107], v[96:99], v[0:15]
    v_exp_f32 v54, v54
    v_exp_f32 v55, v55
    v_exp_f32 v56, v56
    v_exp_f32 v57, v57
    v_smfmac_f32_32x32x32_bf16 v[80:95], v[120:123], v[48:55], v236
    v_exp_f32 v58, v58
    v_exp_f32 v59, v59
    v_exp_f32 v60, v60
    v_exp_f32 v61, v61
    v_mfma_f32_32x32x16_bf16 v[16:31], v[104:107], v[100:103], v[16:31]
    v_exp_f32 v62, v62
    v_exp_f32 v63, v63
    s_cmp_ge_u32 s24, 4
    s_cbranch_scc1 L_pf1
    buffer_load_dword v140, v141, s[12:15], s41 offen offset:128
    s_add_u32 s41, s41, 294912
L_pf1:
    v_add_u32 v237, 38912, v237
    v_add_u32 v238, 38912, v238
    v_add_u32 v239, 38912, v239
    v_exp_f32 v0, v0
    v_exp_f32 v1, v1
    s_waitcnt lgkmcnt(0)
    v_smfmac_f32_32x32x32_bf16 v[80:95], v[124:127], v[56:63], v236
    ds_read_b64_tr_b16 v[120:121], v238 offset:5888
    ds_read_b64_tr_b16 v[122:123], v238 offset:6048
    v_exp_f32 v2, v2
    v_exp_f32 v3, v3
    v_exp_f32 v4, v4
    v_exp_f32 v5, v5
    v_mfma_f32_32x32x4_2b_bf16 v[32:63], v[234:235], v[232:233], 0
    ds_read_b32 v234, v239 offset:13824
    v_exp_f32 v6, v6
    v_exp_f32 v7, v7
    v_exp_f32 v8, v8
    v_exp_f32 v9, v9
    v_exp_f32 v10, v10
    v_exp_f32 v11, v11
    v_exp_f32 v12, v12
    v_exp_f32 v13, v13
    v_smfmac_f32_32x32x32_bf16 v[64:79], v[112:115], v[0:7], v236
    ds_read_b64_tr_b16 v[124:125], v238 offset:6528
    ds_read_b64_tr_b16 v[126:127], v238 offset:6688
    v_exp_f32 v14, v14
    v_exp_f32 v15, v15
    v_exp_f32 v16, v16
    v_exp_f32 v17, v17
    v_smfmac_f32_32x32x32_bf16 v[64:79], v[116:119], v[8:15], v236
    ds_read_b128 v[104:107], v237 offset:9728
    v_exp_f32 v18, v18
    v_exp_f32 v19, v19
    v_exp_f32 v20, v20
    v_exp_f32 v21, v21
    v_mfma_f32_32x32x16_bf16 v[32:47], v[108:111], v[96:99], v[32:47]
    v_exp_f32 v22, v22
    v_exp_f32 v23, v23
    v_exp_f32 v24, v24
    v_exp_f32 v25, v25
    v_smfmac_f32_32x32x32_bf16 v[80:95], v[112:115], v[16:23], v236
    v_exp_f32 v26, v26
    v_exp_f32 v27, v27
    v_exp_f32 v28, v28
    v_exp_f32 v29, v29
    v_mfma_f32_32x32x16_bf16 v[48:63], v[108:111], v[100:103], v[48:63]
    v_exp_f32 v30, v30
    v_exp_f32 v31, v31
    v_exp_f32 v32, v32
    v_exp_f32 v33, v33
    s_waitcnt lgkmcnt(0)
    v_smfmac_f32_32x32x32_bf16 v[80:95], v[116:119], v[24:31], v236
    ds_read_b64_tr_b16 v[112:113], v238 offset:14336
    ds_read_b64_tr_b16 v[114:115], v238 offset:14496
    v_exp_f32 v34, v34
    v_exp_f32 v35, v35
    v_exp_f32 v36, v36
    v_exp_f32 v37, v37
    v_mfma_f32_32x32x4_2b_bf16 v[0:31], v[234:235], v[232:233], 0
    ds_read_b32 v234, v239 offset:13952
    v_exp_f32 v38, v38
    v_exp_f32 v39, v39
    v_exp_f32 v40, v40
    v_exp_f32 v41, v41
    v_exp_f32 v42, v42
    v_exp_f32 v43, v43
    v_exp_f32 v44, v44
    v_exp_f32 v45, v45
    v_smfmac_f32_32x32x32_bf16 v[64:79], v[120:123], v[32:39], v236
    ds_read_b64_tr_b16 v[116:117], v238 offset:14976
    ds_read_b64_tr_b16 v[118:119], v238 offset:15136
    v_exp_f32 v46, v46
    v_exp_f32 v47, v47
    v_exp_f32 v48, v48
    v_exp_f32 v49, v49
    v_smfmac_f32_32x32x32_bf16 v[64:79], v[124:127], v[40:47], v236
    ds_read_b128 v[108:111], v237 offset:10752
    v_exp_f32 v50, v50
    v_exp_f32 v51, v51
    v_exp_f32 v52, v52
    v_exp_f32 v53, v53
    v_mfma_f32_32x32x16_bf16 v[0:15], v[104:107], v[96:99], v[0:15]
    v_exp_f32 v54, v54
    v_exp_f32 v55, v55
    v_exp_f32 v56, v56
    v_exp_f32 v57, v57
    v_smfmac_f32_32x32x32_bf16 v[80:95], v[120:123], v[48:55], v236
    v_exp_f32 v58, v58
    v_exp_f32 v59, v59
    v_exp_f32 v60, v60
    v_exp_f32 v61, v61
    v_mfma_f32_32x32x16_bf16 v[16:31], v[104:107], v[100:103], v[16:31]
    v_exp_f32 v62, v62
    v_exp_f32 v63, v63
    s_cmp_ge_u32 s24, 4
    s_cbranch_scc1 L_pf2
    buffer_load_dword v140, v141, s[12:15], s41 offen offset:0
L_pf2:
    v_exp_f32 v0, v0
    v_exp_f32 v1, v1
    s_waitcnt lgkmcnt(0)
    v_smfmac_f32_32x32x32_bf16 v[80:95], v[124:127], v[56:63], v236
    ds_read_b64_tr_b16 v[120:121], v238 offset:15616
    ds_read_b64_tr_b16 v[122:123], v238 offset:15776
    v_exp_f32 v2, v2
    v_exp_f32 v3, v3
    v_exp_f32 v4, v4
    v_exp_f32 v5, v5
    v_mfma_f32_32x32x4_2b_bf16 v[32:63], v[234:235], v[232:233], 0
    ds_read_b32 v234, v239 offset:23552
    v_exp_f32 v6, v6
    v_exp_f32 v7, v7
    v_exp_f32 v8, v8
    v_exp_f32 v9, v9
    v_exp_f32 v10, v10
    v_exp_f32 v11, v11
    v_exp_f32 v12, v12
    v_exp_f32 v13, v13
    v_smfmac_f32_32x32x32_bf16 v[64:79], v[112:115], v[0:7], v236
    ds_read_b64_tr_b16 v[124:125], v238 offset:16256
    ds_read_b64_tr_b16 v[126:127], v238 offset:16416
    v_exp_f32 v14, v14
    v_exp_f32 v15, v15
    v_exp_f32 v16, v16
    v_exp_f32 v17, v17
    v_smfmac_f32_32x32x32_bf16 v[64:79], v[116:119], v[8:15], v236
    ds_read_b128 v[104:107], v237 offset:19456
    v_exp_f32 v18, v18
    v_exp_f32 v19, v19
    v_exp_f32 v20, v20
    v_exp_f32 v21, v21
    v_mfma_f32_32x32x16_bf16 v[32:47], v[108:111], v[96:99], v[32:47]
    v_exp_f32 v22, v22
    v_exp_f32 v23, v23
    v_exp_f32 v24, v24
    v_exp_f32 v25, v25
    v_smfmac_f32_32x32x32_bf16 v[80:95], v[112:115], v[16:23], v236
    v_exp_f32 v26, v26
    v_exp_f32 v27, v27
    v_exp_f32 v28, v28
    v_exp_f32 v29, v29
    v_mfma_f32_32x32x16_bf16 v[48:63], v[108:111], v[100:103], v[48:63]
    v_exp_f32 v30, v30
    v_exp_f32 v31, v31
    v_exp_f32 v32, v32
    v_exp_f32 v33, v33
    s_waitcnt lgkmcnt(0)
    v_smfmac_f32_32x32x32_bf16 v[80:95], v[116:119], v[24:31], v236
    ds_read_b64_tr_b16 v[112:113], v238 offset:24064
    ds_read_b64_tr_b16 v[114:115], v238 offset:24224
    v_exp_f32 v34, v34
    v_exp_f32 v35, v35
    v_exp_f32 v36, v36
    v_exp_f32 v37, v37
    v_mfma_f32_32x32x4_2b_bf16 v[0:31], v[234:235], v[232:233], 0
    ds_read_b32 v234, v239 offset:23680
    v_exp_f32 v38, v38
    v_exp_f32 v39, v39
    v_exp_f32 v40, v40
    v_exp_f32 v41, v41
    v_exp_f32 v42, v42
    v_exp_f32 v43, v43
    v_exp_f32 v44, v44
    v_exp_f32 v45, v45
    v_smfmac_f32_32x32x32_bf16 v[64:79], v[120:123], v[32:39], v236
    ds_read_b64_tr_b16 v[116:117], v238 offset:24704
    ds_read_b64_tr_b16 v[118:119], v238 offset:24864
    v_exp_f32 v46, v46
    v_exp_f32 v47, v47
    v_exp_f32 v48, v48
    v_exp_f32 v49, v49
    v_smfmac_f32_32x32x32_bf16 v[64:79], v[124:127], v[40:47], v236
    ds_read_b128 v[108:111], v237 offset:20480
    v_exp_f32 v50, v50
    v_exp_f32 v51, v51
    v_exp_f32 v52, v52
    v_exp_f32 v53, v53
    v_mfma_f32_32x32x16_bf16 v[0:15], v[104:107], v[96:99], v[0:15]
    v_exp_f32 v54, v54
    v_exp_f32 v55, v55
    v_exp_f32 v56, v56
    v_exp_f32 v57, v57
    v_smfmac_f32_32x32x32_bf16 v[80:95], v[120:123], v[48:55], v236
    v_exp_f32 v58, v58
    v_exp_f32 v59, v59
    v_exp_f32 v60, v60
    v_exp_f32 v61, v61
    v_mfma_f32_32x32x16_bf16 v[16:31], v[104:107], v[100:103], v[16:31]
    v_exp_f32 v62, v62
    v_exp_f32 v63, v63
    s_cmp_ge_u32 s24, 4
    s_cbranch_scc1 L_pf3
    buffer_load_dword v140, v141, s[12:15], s41 offen offset:128
    s_add_u32 s41, s41, 294912
L_pf3:
    v_exp_f32 v0, v0
    v_exp_f32 v1, v1
    s_waitcnt lgkmcnt(0)
    v_smfmac_f32_32x32x32_bf16 v[80:95], v[124:127], v[56:63], v236
    ds_read_b64_tr_b16 v[120:121], v238 offset:25344
    ds_read_b64_tr_b16 v[122:123], v238 offset:25504
    v_exp_f32 v2, v2
    v_exp_f32 v3, v3
    v_exp_f32 v4, v4
    v_exp_f32 v5, v5
    v_mfma_f32_32x32x4_2b_bf16 v[32:63], v[234:235], v[232:233], 0
    ds_read_b32 v234, v239 offset:33280
    v_exp_f32 v6, v6
    v_exp_f32 v7, v7
    v_exp_f32 v8, v8
    v_exp_f32 v9, v9
    v_exp_f32 v10, v10
    v_exp_f32 v11, v11
    v_exp_f32 v12, v12
    v_exp_f32 v13, v13
    v_smfmac_f32_32x32x32_bf16 v[64:79], v[112:115], v[0:7], v236
    ds_read_b64_tr_b16 v[124:125], v238 offset:25984
    ds_read_b64_tr_b16 v[126:127], v238 offset:26144
    v_exp_f32 v14, v14
    v_exp_f32 v15, v15
    v_exp_f32 v16, v16
    v_exp_f32 v17, v17
    v_smfmac_f32_32x32x32_bf16 v[64:79], v[116:119], v[8:15], v236
    ds_read_b128 v[104:107], v237 offset:29184
    v_exp_f32 v18, v18
    v_exp_f32 v19, v19
    v_exp_f32 v20, v20
    v_exp_f32 v21, v21
    v_mfma_f32_32x32x16_bf16 v[32:47], v[108:111], v[96:99], v[32:47]
    v_exp_f32 v22, v22
    v_exp_f32 v23, v23
    v_exp_f32 v24, v24
    v_exp_f32 v25, v25
    v_smfmac_f32_32x32x32_bf16 v[80:95], v[112:115], v[16:23], v236
    v_exp_f32 v26, v26
    v_exp_f32 v27, v27
    v_exp_f32 v28, v28
    v_exp_f32 v29, v29
    v_mfma_f32_32x32x16_bf16 v[48:63], v[108:111], v[100:103], v[48:63]
    v_exp_f32 v30, v30
    v_exp_f32 v31, v31
    v_exp_f32 v32, v32
    v_exp_f32 v33, v33
    s_waitcnt lgkmcnt(0)
    v_smfmac_f32_32x32x32_bf16 v[80:95], v[116:119], v[24:31], v236
    ds_read_b64_tr_b16 v[112:113], v238 offset:33792
    ds_read_b64_tr_b16 v[114:115], v238 offset:33952
    v_exp_f32 v34, v34
    v_exp_f32 v35, v35
    v_exp_f32 v36, v36
    v_exp_f32 v37, v37
    v_mfma_f32_32x32x4_2b_bf16 v[0:31], v[234:235], v[232:233], 0
    ds_read_b32 v234, v239 offset:33408
    v_exp_f32 v38, v38
    v_exp_f32 v39, v39
    v_exp_f32 v40, v40
    v_exp_f32 v41, v41
    v_exp_f32 v42, v42
    v_exp_f32 v43, v43
    v_exp_f32 v44, v44
    v_exp_f32 v45, v45
    v_smfmac_f32_32x32x32_bf16 v[64:79], v[120:123], v[32:39], v236
    ds_read_b64_tr_b16 v[116:117], v238 offset:34432
    ds_read_b64_tr_b16 v[118:119], v238 offset:34592
    v_exp_f32 v46, v46
    v_exp_f32 v47, v47
    v_exp_f32 v48, v48
    v_exp_f32 v49, v49
    v_smfmac_f32_32x32x32_bf16 v[64:79], v[124:127], v[40:47], v236
    ds_read_b128 v[108:111], v237 offset:30208
    v_exp_f32 v50, v50
    v_exp_f32 v51, v51
    v_exp_f32 v52, v52
    v_exp_f32 v53, v53
    v_mfma_f32_32x32x16_bf16 v[0:15], v[104:107], v[96:99], v[0:15]
    v_exp_f32 v54, v54
    v_exp_f32 v55, v55
    v_exp_f32 v56, v56
    v_exp_f32 v57, v57
    v_smfmac_f32_32x32x32_bf16 v[80:95], v[120:123], v[48:55], v236
    v_exp_f32 v58, v58
    v_exp_f32 v59, v59
    v_exp_f32 v60, v60
    v_exp_f32 v61, v61
    v_mfma_f32_32x32x16_bf16 v[16:31], v[104:107], v[100:103], v[16:31]
    v_exp_f32 v62, v62
    v_exp_f32 v63, v63
    s_cmp_ge_u32 s24, 4
    s_cbranch_scc1 L_pf4
    buffer_load_dword v140, v141, s[12:15], s41 offen
    buffer_load_dword v140, v141, s[12:15], s41 offen offset:128
L_pf4:
    v_exp_f32 v0, v0
    v_exp_f32 v1, v1
    s_waitcnt lgkmcnt(0)
    v_smfmac_f32_32x32x32_bf16 v[80:95], v[124:127], v[56:63], v236
    ds_read_b64_tr_b16 v[120:121], v238 offset:35072
    ds_read_b64_tr_b16 v[122:123], v238 offset:35232
    v_exp_f32 v2, v2
    v_exp_f32 v3, v3
    v_exp_f32 v4, v4
    v_exp_f32 v5, v5
    v_mfma_f32_32x32x4_2b_bf16 v[32:63], v[234:235], v[232:233], 0
    ds_read_b32 v234, v239 offset:43008
    v_exp_f32 v6, v6
    v_exp_f32 v7, v7
    v_exp_f32 v8, v8
    v_exp_f32 v9, v9
    v_exp_f32 v10, v10
    v_exp_f32 v11, v11
    v_exp_f32 v12, v12
    v_exp_f32 v13, v13
    v_smfmac_f32_32x32x32_bf16 v[64:79], v[112:115], v[0:7], v236
    ds_read_b64_tr_b16 v[124:125], v238 offset:35712
    ds_read_b64_tr_b16 v[126:127], v238 offset:35872
    v_exp_f32 v14, v14
    v_exp_f32 v15, v15
    v_exp_f32 v16, v16
    v_exp_f32 v17, v17
    v_smfmac_f32_32x32x32_bf16 v[64:79], v[116:119], v[8:15], v236
    ds_read_b128 v[104:107], v237 offset:38912
    v_exp_f32 v18, v18
    v_exp_f32 v19, v19
    v_exp_f32 v20, v20
    v_exp_f32 v21, v21
    v_mfma_f32_32x32x16_bf16 v[32:47], v[108:111], v[96:99], v[32:47]
    v_exp_f32 v22, v22
    v_exp_f32 v23, v23
    v_exp_f32 v24, v24
    v_exp_f32 v25, v25
    v_smfmac_f32_32x32x32_bf16 v[80:95], v[112:115], v[16:23], v236
    v_exp_f32 v26, v26
    v_exp_f32 v27, v27
    v_exp_f32 v28, v28
    v_exp_f32 v29, v29
    v_mfma_f32_32x32x16_bf16 v[48:63], v[108:111], v[100:103], v[48:63]
    v_exp_f32 v30, v30
    v_exp_f32 v31, v31
    v_exp_f32 v32, v32
    v_exp_f32 v33, v33
    s_waitcnt lgkmcnt(0)
    v_smfmac_f32_32x32x32_bf16 v[80:95], v[116:119], v[24:31], v236
    ds_read_b64_tr_b16 v[112:113], v238 offset:43520
    ds_read_b64_tr_b16 v[114:115], v238 offset:43680
    v_exp_f32 v34, v34
    v_exp_f32 v35, v35
    v_exp_f32 v36, v36
    v_exp_f32 v37, v37
    v_mfma_f32_32x32x4_2b_bf16 v[0:31], v[234:235], v[232:233], 0
    ds_read_b32 v234, v239 offset:43136
    v_exp_f32 v38, v38
    v_exp_f32 v39, v39
    v_exp_f32 v40, v40
    v_exp_f32 v41, v41
    v_exp_f32 v42, v42
    v_exp_f32 v43, v43
    v_exp_f32 v44, v44
    v_exp_f32 v45, v45
    v_smfmac_f32_32x32x32_bf16 v[64:79], v[120:123], v[32:39], v236
    ds_read_b64_tr_b16 v[116:117], v238 offset:44160
    ds_read_b64_tr_b16 v[118:119], v238 offset:44320
    v_exp_f32 v46, v46
    v_exp_f32 v47, v47
    v_exp_f32 v48, v48
    v_exp_f32 v49, v49
    v_smfmac_f32_32x32x32_bf16 v[64:79], v[124:127], v[40:47], v236
    ds_read_b128 v[108:111], v237 offset:39936
    v_exp_f32 v50, v50
    v_exp_f32 v51, v51
    v_exp_f32 v52, v52
    v_exp_f32 v53, v53
    v_mfma_f32_32x32x16_bf16 v[0:15], v[104:107], v[96:99], v[0:15]
    v_exp_f32 v54, v54
    v_exp_f32 v55, v55
    v_exp_f32 v56, v56
    v_exp_f32 v57, v57
    v_smfmac_f32_32x32x32_bf16 v[80:95], v[120:123], v[48:55], v236
    v_exp_f32 v58, v58
    v_exp_f32 v59, v59
    v_exp_f32 v60, v60
    v_exp_f32 v61, v61
    v_mfma_f32_32x32x16_bf16 v[16:31], v[104:107], v[100:103], v[16:31]
    v_exp_f32 v62, v62
    v_exp_f32 v63, v63
    s_cmp_ge_u32 s24, 3
    s_cbranch_scc1 L_p3l
    s_and_b32 s38, s2, 3
    s_lshl_b32 s46, s38, 13
    s_add_u32 s46, s46, 14516224
    v_lshlrev_b32 v142, 7, v250
    s_mov_b32 s30, 0
L_s3_poll:
    buffer_load_dword v143, v142, s[8:11], s46 offen sc1
    s_waitcnt vmcnt(0)
    v_xor_b32 v143, s25, v143
    v_cmp_ne_u32 vcc, 0, v143
    s_add_u32 s30, s30, 1
    s_cmp_gt_u32 s30, 65536
    s_cbranch_scc1 L_s3_pdone
    s_cmp_eq_u64 vcc, 0
    s_cbranch_scc1 L_s3_pdone
    s_sleep 2
    s_branch L_s3_poll
L_s3_pdone:
    s_lshl_b32 s46, s38, 11
    s_add_u32 s46, s46, 14540800
    v_and_b32 v142, 1920, v142
    s_mov_b32 s30, 0
L_s3b_poll:
    buffer_load_dword v143, v142, s[8:11], s46 offen sc1
    s_waitcnt vmcnt(0)
    v_xor_b32 v143, s25, v143
    v_cmp_ne_u32 vcc, 0, v143
    s_add_u32 s30, s30, 1
    s_cmp_gt_u32 s30, 65536
    s_cbranch_scc1 L_s3b_pdone
    s_cmp_eq_u64 vcc, 0
    s_cbranch_scc1 L_s3b_pdone
    s_sleep 2
    s_branch L_s3b_poll
L_s3b_pdone:
    s_mov_b64 s[20:21], s[70:71]
    s_mov_b32 s22, 2359296
    s_mov_b32 s23, 0x20000
    s_lshr_b32 s37, s2, 2
    s_mul_i32 s37, s37, 36864
    s_mul_i32 s38, s38, 288
    s_add_u32 s37, s37, s38
    s_add_u32 s38, s37, 4608
    s_mul_i32 s44, s2, 9216
    s_add_u32 s44, s44, 12058624
    v_lshrrev_b32 v142, 2, v252
    v_and_b32 v143, 3, v252
    v_lshlrev_b32 v144, 8, v142
    v_lshl_add_u32 v144, v143, 4, v144
    v_mul_u32_u24 v143, 9216, v143
    v_lshl_add_u32 v142, v142, 3, v143
    v_cmp_gt_u32 vcc, 144, v252
    s_and_b64 exec, exec, vcc
    buffer_load_dwordx4 v[200:203], v144, s[8:11], s44 offen offset:0 sc1
    buffer_load_dwordx4 v[204:207], v144, s[8:11], s44 offen offset:64 sc1
    buffer_load_dwordx4 v[208:211], v144, s[8:11], s44 offen offset:128 sc1
    buffer_load_dwordx4 v[212:215], v144, s[8:11], s44 offen offset:192 sc1
    buffer_load_dwordx2 v[216:217], v142, s[20:23], s37 offen offset:0
    buffer_load_dwordx2 v[218:219], v142, s[20:23], s37 offen offset:1152
    buffer_load_dwordx2 v[220:221], v142, s[20:23], s37 offen offset:2304
    buffer_load_dwordx2 v[222:223], v142, s[20:23], s37 offen offset:3456
    buffer_load_dwordx2 v[224:225], v142, s[20:23], s38 offen offset:0
    buffer_load_dwordx2 v[226:227], v142, s[20:23], s38 offen offset:1152
    buffer_load_dwordx2 v[228:229], v142, s[20:23], s38 offen offset:2304
    buffer_load_dwordx2 v[230:231], v142, s[20:23], s38 offen offset:3456
    s_mov_b64 exec, -1
L_p3l:
    v_add_u32 v237, 38912, v237
    v_add_u32 v238, 38912, v238
    v_add_u32 v239, 38912, v239
    v_exp_f32 v0, v0
    v_exp_f32 v1, v1
    s_waitcnt lgkmcnt(0)
    v_smfmac_f32_32x32x32_bf16 v[80:95], v[124:127], v[56:63], v236
    ds_read_b64_tr_b16 v[120:121], v238 offset:5888
    ds_read_b64_tr_b16 v[122:123], v238 offset:6048
    v_exp_f32 v2, v2
    v_exp_f32 v3, v3
    v_exp_f32 v4, v4
    v_exp_f32 v5, v5
    v_mfma_f32_32x32x4_2b_bf16 v[32:63], v[234:235], v[232:233], 0
    ds_read_b32 v234, v239 offset:13824
    v_exp_f32 v6, v6
    v_exp_f32 v7, v7
    v_exp_f32 v8, v8
    v_exp_f32 v9, v9
    v_exp_f32 v10, v10
    v_exp_f32 v11, v11
    v_exp_f32 v12, v12
    v_exp_f32 v13, v13
    v_smfmac_f32_32x32x32_bf16 v[64:79], v[112:115], v[0:7], v236
    ds_read_b64_tr_b16 v[124:125], v238 offset:6528
    ds_read_b64_tr_b16 v[126:127], v238 offset:6688
    v_exp_f32 v14, v14
    v_exp_f32 v15, v15
    v_exp_f32 v16, v16
    v_exp_f32 v17, v17
    v_smfmac_f32_32x32x32_bf16 v[64:79], v[116:119], v[8:15], v236
    ds_read_b128 v[104:107], v237 offset:9728
    v_exp_f32 v18, v18
    v_exp_f32 v19, v19
    v_exp_f32 v20, v20
    v_exp_f32 v21, v21
    v_mfma_f32_32x32x16_bf16 v[32:47], v[108:111], v[96:99], v[32:47]
    v_exp_f32 v22, v22
    v_exp_f32 v23, v23
    v_exp_f32 v24, v24
    v_exp_f32 v25, v25
    v_smfmac_f32_32x32x32_bf16 v[80:95], v[112:115], v[16:23], v236
    v_exp_f32 v26, v26
    v_exp_f32 v27, v27
    v_exp_f32 v28, v28
    v_exp_f32 v29, v29
    v_mfma_f32_32x32x16_bf16 v[48:63], v[108:111], v[100:103], v[48:63]
    v_exp_f32 v30, v30
    v_exp_f32 v31, v31
    v_exp_f32 v32, v32
    v_exp_f32 v33, v33
    s_waitcnt lgkmcnt(0)
    v_smfmac_f32_32x32x32_bf16 v[80:95], v[116:119], v[24:31], v236
    ds_read_b64_tr_b16 v[112:113], v238 offset:14336
    ds_read_b64_tr_b16 v[114:115], v238 offset:14496
    v_exp_f32 v34, v34
    v_exp_f32 v35, v35
    v_exp_f32 v36, v36
    v_exp_f32 v37, v37
    v_mfma_f32_32x32x4_2b_bf16 v[0:31], v[234:235], v[232:233], 0
    ds_read_b32 v234, v239 offset:13952
    v_exp_f32 v38, v38
    v_exp_f32 v39, v39
    v_exp_f32 v40, v40
    v_exp_f32 v41, v41
    v_exp_f32 v42, v42
    v_exp_f32 v43, v43
    v_exp_f32 v44, v44
    v_exp_f32 v45, v45
    v_smfmac_f32_32x32x32_bf16 v[64:79], v[120:123], v[32:39], v236
    ds_read_b64_tr_b16 v[116:117], v238 offset:14976
    ds_read_b64_tr_b16 v[118:119], v238 offset:15136
    v_exp_f32 v46, v46
    v_exp_f32 v47, v47
    v_exp_f32 v48, v48
    v_exp_f32 v49, v49
    v_smfmac_f32_32x32x32_bf16 v[64:79], v[124:127], v[40:47], v236
    ds_read_b128 v[108:111], v237 offset:10752
    v_exp_f32 v50, v50
    v_exp_f32 v51, v51
    v_exp_f32 v52, v52
    v_exp_f32 v53, v53
    v_mfma_f32_32x32x16_bf16 v[0:15], v[104:107], v[96:99], v[0:15]
    v_exp_f32 v54, v54
    v_exp_f32 v55, v55
    v_exp_f32 v56, v56
    v_exp_f32 v57, v57
    v_smfmac_f32_32x32x32_bf16 v[80:95], v[120:123], v[48:55], v236
    v_exp_f32 v58, v58
    v_exp_f32 v59, v59
    v_exp_f32 v60, v60
    v_exp_f32 v61, v61
    v_mfma_f32_32x32x16_bf16 v[16:31], v[104:107], v[100:103], v[16:31]
    v_exp_f32 v62, v62
    v_exp_f32 v63, v63
    v_exp_f32 v0, v0
    v_exp_f32 v1, v1
    s_waitcnt lgkmcnt(0)
    v_smfmac_f32_32x32x32_bf16 v[80:95], v[124:127], v[56:63], v236
    ds_read_b64_tr_b16 v[120:121], v238 offset:15616
    ds_read_b64_tr_b16 v[122:123], v238 offset:15776
    v_exp_f32 v2, v2
    v_exp_f32 v3, v3
    v_exp_f32 v4, v4
    v_exp_f32 v5, v5
    v_mfma_f32_32x32x4_2b_bf16 v[32:63], v[234:235], v[232:233], 0
    ds_read_b32 v234, v239 offset:23552
    v_exp_f32 v6, v6
    v_exp_f32 v7, v7
    v_exp_f32 v8, v8
    v_exp_f32 v9, v9
    v_exp_f32 v10, v10
    v_exp_f32 v11, v11
    v_exp_f32 v12, v12
    v_exp_f32 v13, v13
    v_smfmac_f32_32x32x32_bf16 v[64:79], v[112:115], v[0:7], v236
    ds_read_b64_tr_b16 v[124:125], v238 offset:16256
    ds_read_b64_tr_b16 v[126:127], v238 offset:16416
    v_exp_f32 v14, v14
    v_exp_f32 v15, v15
    v_exp_f32 v16, v16
    v_exp_f32 v17, v17
    v_smfmac_f32_32x32x32_bf16 v[64:79], v[116:119], v[8:15], v236
    ds_read_b128 v[104:107], v237 offset:19456
    v_exp_f32 v18, v18
    v_exp_f32 v19, v19
    v_exp_f32 v20, v20
    v_exp_f32 v21, v21
    v_mfma_f32_32x32x16_bf16 v[32:47], v[108:111], v[96:99], v[32:47]
    v_exp_f32 v22, v22
    v_exp_f32 v23, v23
    v_exp_f32 v24, v24
    v_exp_f32 v25, v25
    v_smfmac_f32_32x32x32_bf16 v[80:95], v[112:115], v[16:23], v236
    v_exp_f32 v26, v26
    v_exp_f32 v27, v27
    v_exp_f32 v28, v28
    v_exp_f32 v29, v29
    v_mfma_f32_32x32x16_bf16 v[48:63], v[108:111], v[100:103], v[48:63]
    v_exp_f32 v30, v30
    v_exp_f32 v31, v31
    v_exp_f32 v32, v32
    v_exp_f32 v33, v33
    s_waitcnt lgkmcnt(0)
    v_smfmac_f32_32x32x32_bf16 v[80:95], v[116:119], v[24:31], v236
    ds_read_b64_tr_b16 v[112:113], v238 offset:24064
    ds_read_b64_tr_b16 v[114:115], v238 offset:24224
    v_exp_f32 v34, v34
    v_exp_f32 v35, v35
    v_exp_f32 v36, v36
    v_exp_f32 v37, v37
    v_mfma_f32_32x32x4_2b_bf16 v[0:31], v[234:235], v[232:233], 0
    ds_read_b32 v234, v239 offset:23680
    v_exp_f32 v38, v38
    v_exp_f32 v39, v39
    v_exp_f32 v40, v40
    v_exp_f32 v41, v41
    v_exp_f32 v42, v42
    v_exp_f32 v43, v43
    v_exp_f32 v44, v44
    v_exp_f32 v45, v45
    v_smfmac_f32_32x32x32_bf16 v[64:79], v[120:123], v[32:39], v236
    ds_read_b64_tr_b16 v[116:117], v238 offset:24704
    ds_read_b64_tr_b16 v[118:119], v238 offset:24864
    v_exp_f32 v46, v46
    v_exp_f32 v47, v47
    v_exp_f32 v48, v48
    v_exp_f32 v49, v49
    v_smfmac_f32_32x32x32_bf16 v[64:79], v[124:127], v[40:47], v236
    ds_read_b128 v[108:111], v237 offset:20480
    v_exp_f32 v50, v50
    v_exp_f32 v51, v51
    v_exp_f32 v52, v52
    v_exp_f32 v53, v53
    v_mfma_f32_32x32x16_bf16 v[0:15], v[104:107], v[96:99], v[0:15]
    v_exp_f32 v54, v54
    v_exp_f32 v55, v55
    v_exp_f32 v56, v56
    v_exp_f32 v57, v57
    v_smfmac_f32_32x32x32_bf16 v[80:95], v[120:123], v[48:55], v236
    v_exp_f32 v58, v58
    v_exp_f32 v59, v59
    v_exp_f32 v60, v60
    v_exp_f32 v61, v61
    v_mfma_f32_32x32x16_bf16 v[16:31], v[104:107], v[100:103], v[16:31]
    v_exp_f32 v62, v62
    v_exp_f32 v63, v63
    s_cmp_ge_u32 s24, 4
    s_cbranch_scc1 L_wy
    s_cmp_ge_u32 s2, 192
    s_cbranch_scc1 L_wy
    s_mov_b64 s[12:13], s[68:69]
    s_mov_b32 s14, 663552
    s_mov_b32 s15, 0x20000
    v_add_u32 v243, 0, v250
    v_mul_u32_u24 v244, 171, v243
    v_lshrrev_b32 v244, 11, v244
    v_mul_u32_u24 v244, 960, v244
    v_lshl_add_u32 v240, v243, 4, v244
    v_add_u32 v243, 64, v250
    v_mul_u32_u24 v244, 171, v243
    v_lshrrev_b32 v244, 11, v244
    v_mul_u32_u24 v244, 960, v244
    v_lshl_add_u32 v241, v243, 4, v244
    v_add_u32 v243, 128, v250
    v_mul_u32_u24 v244, 171, v243
    v_lshrrev_b32 v244, 11, v244
    v_mul_u32_u24 v244, 960, v244
    v_lshl_add_u32 v242, v243, 4, v244
    s_lshr_b32 s40, s2, 3
    s_mul_i32 s41, s40, 43
    s_lshr_b32 s41, s41, 8
    s_mul_i32 s41, s41, 6
    s_sub_u32 s41, s40, s41
    s_mul_i32 s41, s41, 192
    s_cmp_ge_u32 s40, 24
    s_cselect_b32 s41, 0x40000000, s41
    s_mul_i32 s48, s24, 3072
    s_cmp_lt_u32 s24, 4
    s_cselect_b32 s50, s48, 0x20000
    s_mul_i32 s49, s24, 18432
    s_add_u32 s49, s49, s41
    s_mov_b32 s37, 0
L_wla:
    s_mov_b32 m0, s48
    s_add_u32 s37, s37, 1
    buffer_load_dwordx4 v240, s[12:15], s49 offen lds
    s_add_u32 m0, s48, 1024
    s_nop 0
    buffer_load_dwordx4 v241, s[12:15], s49 offen lds
    s_add_u32 m0, s48, 2048
    s_add_u32 s48, s48, 12288
    buffer_load_dwordx4 v242, s[12:15], s49 offen lds
    s_add_u32 s49, s49, 73728
    s_cmp_lt_u32 s37, 5
    s_cbranch_scc1 L_wla
    s_barrier
    s_mov_b32 s37, 0
L_wlb:
    s_mov_b32 m0, s48
    s_add_u32 s37, s37, 1
    buffer_load_dwordx4 v240, s[12:15], s49 offen lds
    s_add_u32 m0, s48, 1024
    s_nop 0
    buffer_load_dwordx4 v241, s[12:15], s49 offen lds
    s_add_u32 m0, s48, 2048
    s_add_u32 s48, s48, 12288
    buffer_load_dwordx4 v242, s[12:15], s49 offen lds
    s_add_u32 s49, s49, 73728
    s_cmp_lt_u32 s37, 4
    s_cbranch_scc1 L_wlb
    s_branch L_wz
L_wy:
    s_barrier
L_wz:
    v_exp_f32 v0, v0
    v_exp_f32 v1, v1
    s_waitcnt lgkmcnt(0)
    v_smfmac_f32_32x32x32_bf16 v[80:95], v[124:127], v[56:63], v236
    ds_read_b64_tr_b16 v[120:121], v238 offset:25344
    ds_read_b64_tr_b16 v[122:123], v238 offset:25504
    v_exp_f32 v2, v2
    v_exp_f32 v3, v3
    v_exp_f32 v4, v4
    v_exp_f32 v5, v5
    v_mfma_f32_32x32x4_2b_bf16 v[32:63], v[234:235], v[232:233], 0
    ds_read_b32 v234, v239 offset:33280
    v_exp_f32 v6, v6
    v_exp_f32 v7, v7
    v_exp_f32 v8, v8
    v_exp_f32 v9, v9
    v_exp_f32 v10, v10
    v_exp_f32 v11, v11
    v_exp_f32 v12, v12
    v_exp_f32 v13, v13
    v_smfmac_f32_32x32x32_bf16 v[64:79], v[112:115], v[0:7], v236
    ds_read_b64_tr_b16 v[124:125], v238 offset:25984
    ds_read_b64_tr_b16 v[126:127], v238 offset:26144
    v_exp_f32 v14, v14
    v_exp_f32 v15, v15
    v_exp_f32 v16, v16
    v_exp_f32 v17, v17
    v_smfmac_f32_32x32x32_bf16 v[64:79], v[116:119], v[8:15], v236
    ds_read_b128 v[104:107], v237 offset:29184
    v_exp_f32 v18, v18
    v_exp_f32 v19, v19
    v_exp_f32 v20, v20
    v_exp_f32 v21, v21
    v_mfma_f32_32x32x16_bf16 v[32:47], v[108:111], v[96:99], v[32:47]
    v_exp_f32 v22, v22
    v_exp_f32 v23, v23
    v_exp_f32 v24, v24
    v_exp_f32 v25, v25
    v_smfmac_f32_32x32x32_bf16 v[80:95], v[112:115], v[16:23], v236
    v_exp_f32 v26, v26
    v_exp_f32 v27, v27
    v_exp_f32 v28, v28
    v_exp_f32 v29, v29
    v_mfma_f32_32x32x16_bf16 v[48:63], v[108:111], v[100:103], v[48:63]
    v_exp_f32 v30, v30
    v_exp_f32 v31, v31
    v_exp_f32 v32, v32
    v_exp_f32 v33, v33
    s_waitcnt lgkmcnt(0)
    v_smfmac_f32_32x32x32_bf16 v[80:95], v[116:119], v[24:31], v236
    ds_read_b64_tr_b16 v[112:113], v238 offset:33792
    ds_read_b64_tr_b16 v[114:115], v238 offset:33952
    v_exp_f32 v34, v34
    v_exp_f32 v35, v35
    v_exp_f32 v36, v36
    v_exp_f32 v37, v37
    v_mfma_f32_32x32x4_2b_bf16 v[0:31], v[234:235], v[232:233], 0
    ds_read_b32 v234, v239 offset:33408
    v_exp_f32 v38, v38
    v_exp_f32 v39, v39
    v_exp_f32 v40, v40
    v_exp_f32 v41, v41
    v_exp_f32 v42, v42
    v_exp_f32 v43, v43
    v_exp_f32 v44, v44
    v_exp_f32 v45, v45
    v_smfmac_f32_32x32x32_bf16 v[64:79], v[120:123], v[32:39], v236
    ds_read_b64_tr_b16 v[116:117], v238 offset:34432
    ds_read_b64_tr_b16 v[118:119], v238 offset:34592
    v_exp_f32 v46, v46
    v_exp_f32 v47, v47
    v_exp_f32 v48, v48
    v_exp_f32 v49, v49
    v_smfmac_f32_32x32x32_bf16 v[64:79], v[124:127], v[40:47], v236
    ds_read_b128 v[108:111], v237 offset:30208
    v_exp_f32 v50, v50
    v_exp_f32 v51, v51
    v_exp_f32 v52, v52
    v_exp_f32 v53, v53
    v_mfma_f32_32x32x16_bf16 v[0:15], v[104:107], v[96:99], v[0:15]
    v_exp_f32 v54, v54
    v_exp_f32 v55, v55
    v_exp_f32 v56, v56
    v_exp_f32 v57, v57
    v_smfmac_f32_32x32x32_bf16 v[80:95], v[120:123], v[48:55], v236
    v_exp_f32 v58, v58
    v_exp_f32 v59, v59
    v_exp_f32 v60, v60
    v_exp_f32 v61, v61
    v_mfma_f32_32x32x16_bf16 v[16:31], v[104:107], v[100:103], v[16:31]
    v_exp_f32 v62, v62
    v_exp_f32 v63, v63
    v_exp_f32 v0, v0
    v_exp_f32 v1, v1
    s_waitcnt lgkmcnt(0)
    v_smfmac_f32_32x32x32_bf16 v[80:95], v[124:127], v[56:63], v236
    ds_read_b64_tr_b16 v[120:121], v238 offset:35072
    ds_read_b64_tr_b16 v[122:123], v238 offset:35232
    v_exp_f32 v2, v2
    v_exp_f32 v3, v3
    v_exp_f32 v4, v4
    v_exp_f32 v5, v5
    v_mfma_f32_32x32x4_2b_bf16 v[32:63], v[234:235], v[232:233], 0
    ds_read_b32 v234, v239 offset:43008
    v_exp_f32 v6, v6
    v_exp_f32 v7, v7
    v_exp_f32 v8, v8
    v_exp_f32 v9, v9
    v_exp_f32 v10, v10
    v_exp_f32 v11, v11
    v_exp_f32 v12, v12
    v_exp_f32 v13, v13
    v_smfmac_f32_32x32x32_bf16 v[64:79], v[112:115], v[0:7], v236
    ds_read_b64_tr_b16 v[124:125], v238 offset:35712
    ds_read_b64_tr_b16 v[126:127], v238 offset:35872
    v_exp_f32 v14, v14
    v_exp_f32 v15, v15
    v_exp_f32 v16, v16
    v_exp_f32 v17, v17
    v_smfmac_f32_32x32x32_bf16 v[64:79], v[116:119], v[8:15], v236
    ds_read_b128 v[104:107], v237 offset:38912
    v_exp_f32 v18, v18
    v_exp_f32 v19, v19
    v_exp_f32 v20, v20
    v_exp_f32 v21, v21
    v_mfma_f32_32x32x16_bf16 v[32:47], v[108:111], v[96:99], v[32:47]
    v_exp_f32 v22, v22
    v_exp_f32 v23, v23
    v_exp_f32 v24, v24
    v_exp_f32 v25, v25
    v_smfmac_f32_32x32x32_bf16 v[80:95], v[112:115], v[16:23], v236
    v_exp_f32 v26, v26
    v_exp_f32 v27, v27
    v_exp_f32 v28, v28
    v_exp_f32 v29, v29
    v_mfma_f32_32x32x16_bf16 v[48:63], v[108:111], v[100:103], v[48:63]
    v_exp_f32 v30, v30
    v_exp_f32 v31, v31
    v_exp_f32 v32, v32
    v_exp_f32 v33, v33
    s_waitcnt lgkmcnt(0)
    v_smfmac_f32_32x32x32_bf16 v[80:95], v[116:119], v[24:31], v236
    ds_read_b64_tr_b16 v[112:113], v238 offset:43520
    ds_read_b64_tr_b16 v[114:115], v238 offset:43680
    v_exp_f32 v34, v34
    v_exp_f32 v35, v35
    v_exp_f32 v36, v36
    v_exp_f32 v37, v37
    v_mfma_f32_32x32x4_2b_bf16 v[0:31], v[234:235], v[232:233], 0
    ds_read_b32 v234, v239 offset:43136
    v_exp_f32 v38, v38
    v_exp_f32 v39, v39
    v_exp_f32 v40, v40
    v_exp_f32 v41, v41
    v_exp_f32 v42, v42
    v_exp_f32 v43, v43
    v_exp_f32 v44, v44
    v_exp_f32 v45, v45
    v_smfmac_f32_32x32x32_bf16 v[64:79], v[120:123], v[32:39], v236
    ds_read_b64_tr_b16 v[116:117], v238 offset:44160
    ds_read_b64_tr_b16 v[118:119], v238 offset:44320
    v_exp_f32 v46, v46
    v_exp_f32 v47, v47
    v_exp_f32 v48, v48
    v_exp_f32 v49, v49
    v_smfmac_f32_32x32x32_bf16 v[64:79], v[124:127], v[40:47], v236
    ds_read_b128 v[108:111], v237 offset:39936
    v_exp_f32 v50, v50
    v_exp_f32 v51, v51
    v_exp_f32 v52, v52
    v_exp_f32 v53, v53
    v_mfma_f32_32x32x16_bf16 v[0:15], v[104:107], v[96:99], v[0:15]
    v_exp_f32 v54, v54
    v_exp_f32 v55, v55
    v_exp_f32 v56, v56
    v_exp_f32 v57, v57
    v_smfmac_f32_32x32x32_bf16 v[80:95], v[120:123], v[48:55], v236
    v_exp_f32 v58, v58
    v_exp_f32 v59, v59
    v_exp_f32 v60, v60
    v_exp_f32 v61, v61
    v_mfma_f32_32x32x16_bf16 v[16:31], v[104:107], v[100:103], v[16:31]
    v_exp_f32 v62, v62
    v_exp_f32 v63, v63
    s_mul_i32 s37, s24, 3072
    s_add_u32 s37, s37, 110592
    v_smfmac_f32_32x32x32_bf16 v[80:95], v[124:127], v[56:63], v236
    v_add_u32 v128, s37, v251
    s_xor_b32 s38, s24, 4
    s_mul_i32 s38, s38, 3072
    s_add_u32 s38, s38, 110592
    v_add_u32 v129, s38, v251
    s_and_b32 s38, s24, 3
    s_lshl_b32 s38, s38, 2
    s_add_u32 s38, s38, 163812
    v_mov_b32 v130, s38
    v_mov_b32 v131, 1
    s_mul_i32 s39, s32, 36864
    s_lshl_b32 s46, s31, 10
    s_add_u32 s39, s39, 7340032
    s_add_u32 s46, s46, s39
    s_lshl_b32 s47, s31, 7
    s_add_u32 s47, s47, s39
    s_add_u32 s47, s47, 32768
    s_cmp_lt_u32 s24, 4
    s_cbranch_scc0 L_xk1
    ds_write_b128 v128, v[80:83] offset:0
    ds_write_b128 v128, v[84:87] offset:1024
    ds_write_b128 v128, v[88:91] offset:2048
    s_mov_b64 exec, 1
    ds_add_u32 v130, v131
    s_mov_b64 exec, -1
    s_branch L_spX0
L_spX0_s:
    s_sleep 1
L_spX0:
    ds_read_b32 v131, v130
    s_waitcnt lgkmcnt(0)
    v_readfirstlane_b32 s30, v131
    s_cmp_lt_u32 s30, 2
    s_cbranch_scc1 L_spX0_s
    ds_read_b128 v[16:19], v129 offset:0
    ds_read_b128 v[20:23], v129 offset:1024
    ds_read_b128 v[24:27], v129 offset:2048
    s_waitcnt lgkmcnt(0)
    v_pk_add_f32 v[16:17], v[16:17], v[64:65]
    v_pk_add_f32 v[18:19], v[18:19], v[66:67]
    v_pk_add_f32 v[20:21], v[20:21], v[68:69]
    v_pk_add_f32 v[22:23], v[22:23], v[70:71]
    v_pk_add_f32 v[24:25], v[24:25], v[72:73]
    v_pk_add_f32 v[26:27], v[26:27], v[74:75]
    s_branch L_xk2
L_xk1:
    ds_write_b128 v128, v[64:67] offset:0
    ds_write_b128 v128, v[68:71] offset:1024
    ds_write_b128 v128, v[72:75] offset:2048
    s_mov_b64 exec, 1
    ds_add_u32 v130, v131
    s_mov_b64 exec, -1
    s_branch L_spX1
L_spX1_s:
    s_sleep 1
L_spX1:
    ds_read_b32 v131, v130
    s_waitcnt lgkmcnt(0)
    v_readfirstlane_b32 s30, v131
    s_cmp_lt_u32 s30, 2
    s_cbranch_scc1 L_spX1_s
    ds_read_b128 v[16:19], v129 offset:0
    ds_read_b128 v[20:23], v129 offset:1024
    ds_read_b128 v[24:27], v129 offset:2048
    s_waitcnt lgkmcnt(0)
    v_pk_add_f32 v[16:17], v[16:17], v[80:81]
    v_pk_add_f32 v[18:19], v[18:19], v[82:83]
    v_pk_add_f32 v[20:21], v[20:21], v[84:85]
    v_pk_add_f32 v[22:23], v[22:23], v[86:87]
    v_pk_add_f32 v[24:25], v[24:25], v[88:89]
    v_pk_add_f32 v[26:27], v[26:27], v[90:91]
L_xk2:
    v_mov_b32 v4, 0x7f7fffff
    v_mov_b32 v128, v26
    v_mov_b32 v129, v26
    v_add_f32 v130, |v16|, |v17|
    v_add_f32 v0, |v18|, |v19|
    v_permlane32_swap_b32 v128, v129
    v_add_f32 v1, |v20|, |v21|
    v_add_f32 v2, |v22|, |v23|
    v_add_f32 v3, |v24|, |v25|
    v_add_f32 v130, v130, v0
    v_add_f32 v1, v1, v2
    v_add_f32 v130, v130, v1
    v_cmp_nge_f32 vcc, 0x71800000, v128
    v_cmp_nle_f32 s[40:41], v130, v4
    v_cmp_nle_f32 s[42:43], v3, v4
    s_or_b64 s[40:41], vcc, s[40:41]
    v_cmp_nle_f32 vcc, 0x30800000, v128
    s_or_b32 s40, s40, s42
    s_or_b64 s[40:41], vcc, s[40:41]
    s_cbranch_scc1 L_slow
L_afin:
    v_rcp_f32 v128, v128
    v_lshlrev_b32 v129, 2, v250
    v_mul_f32 v16, v16, v128
    v_mul_f32 v17, v17, v128
    v_mul_f32 v18, v18, v128
    v_mul_f32 v19, v19, v128
    v_mul_f32 v20, v20, v128
    v_mul_f32 v21, v21, v128
    v_mul_f32 v22, v22, v128
    v_mul_f32 v23, v23, v128
    v_mul_f32 v24, v24, v128
    v_mul_f32 v25, v25, v128
    v_cvt_pk_bf16_f32 v160, v16, v17
    v_cvt_pk_bf16_f32 v161, v18, v19
    v_cvt_pk_bf16_f32 v162, v20, v21
    v_cvt_pk_bf16_f32 v163, v22, v23
    v_cvt_pk_bf16_f32 v164, v24, v25
    buffer_store_dwordx4 v[160:163], v251, s[8:11], s46 offen sc1
    s_mov_b32 exec_hi, 0
    buffer_store_dword v164, v129, s[8:11], s47 offen sc1
    s_mov_b32 exec_hi, -1
    s_mov_b64 s[16:17], s[82:83]
    s_mov_b32 s18, 4718592
    s_mov_b32 s19, 0x20000
    s_cmp_ge_u32 s24, 4
    s_cbranch_scc1 L_grpY
    v_lshrrev_b32 v0, 2, v252
    v_and_b32 v1, 3, v252
    v_mul_u32_u24 v41, 18432, v1
    v_lshl_add_u32 v41, v0, 3, v41
    s_lshr_b32 s45, s2, 2
    s_mul_i32 s45, s45, 73728
    s_and_b32 s38, s2, 3
    s_mul_i32 s38, s38, 288
    s_add_u32 s45, s45, s38
    s_add_u32 s45, s45, 1152
    s_waitcnt vmcnt(0)
    v_mov_b32 v2, 163780
    v_mov_b32 v3, 1
    s_mov_b64 exec, 1
    ds_add_rtn_u32 v3, v2, v3
    s_mov_b64 exec, -1
    s_waitcnt lgkmcnt(0)
    v_readfirstlane_b32 s30, v3
    s_cmp_lg_u32 s30, 7
    s_cbranch_scc1 L_sgA1
    s_lshl_b32 s26, s2, 7
    s_add_u32 s26, s26, 14483456
    v_mov_b32 v253, s25
    s_mov_b64 exec, 1
    buffer_store_dword v253, v251, s[8:11], s26 offen sc1
    s_mov_b64 exec, -1
L_sgA1:
    s_cmp_eq_u32 s24, 3
    s_cbranch_scc1 L_endf
    v_mov_b32 v2, 163780
    s_branch L_spA1
L_spA1_s:
    s_sleep 1
L_spA1:
    ds_read_b32 v3, v2
    s_waitcnt lgkmcnt(0)
    v_readfirstlane_b32 s30, v3
    s_cmp_lt_u32 s30, 8
    s_cbranch_scc1 L_spA1_s
    v_cmp_gt_u32 vcc, 144, v252
    s_and_b64 exec, exec, vcc
    v_lshlrev_b32 v8, 16, v216
    v_and_b32 v9, 0xffff0000, v216
    v_lshlrev_b32 v4, 16, v200
    v_lshlrev_b32 v5, 16, v204
    v_pk_mul_f32 v[8:9], v[8:9], v[4:5]
    v_cvt_pk_bf16_f32 v16, v8, v9
    v_lshlrev_b32 v10, 16, v217
    v_and_b32 v11, 0xffff0000, v217
    v_lshlrev_b32 v6, 16, v208
    v_lshlrev_b32 v7, 16, v212
    v_pk_mul_f32 v[10:11], v[10:11], v[6:7]
    v_cvt_pk_bf16_f32 v17, v10, v11
    buffer_store_dwordx2 v[16:17], v41, s[16:19], s45 offen
    s_add_u32 s45, s45, 2304
    v_lshlrev_b32 v8, 16, v218
    v_and_b32 v9, 0xffff0000, v218
    v_and_b32 v4, 0xffff0000, v200
    v_and_b32 v5, 0xffff0000, v204
    v_pk_mul_f32 v[8:9], v[8:9], v[4:5]
    v_cvt_pk_bf16_f32 v18, v8, v9
    v_lshlrev_b32 v10, 16, v219
    v_and_b32 v11, 0xffff0000, v219
    v_and_b32 v6, 0xffff0000, v208
    v_and_b32 v7, 0xffff0000, v212
    v_pk_mul_f32 v[10:11], v[10:11], v[6:7]
    v_cvt_pk_bf16_f32 v19, v10, v11
    buffer_store_dwordx2 v[18:19], v41, s[16:19], s45 offen
    s_add_u32 s45, s45, 2304
    v_lshlrev_b32 v8, 16, v220
    v_and_b32 v9, 0xffff0000, v220
    v_lshlrev_b32 v4, 16, v201
    v_lshlrev_b32 v5, 16, v205
    v_pk_mul_f32 v[8:9], v[8:9], v[4:5]
    v_cvt_pk_bf16_f32 v20, v8, v9
    v_lshlrev_b32 v10, 16, v221
    v_and_b32 v11, 0xffff0000, v221
    v_lshlrev_b32 v6, 16, v209
    v_lshlrev_b32 v7, 16, v213
    v_pk_mul_f32 v[10:11], v[10:11], v[6:7]
    v_cvt_pk_bf16_f32 v21, v10, v11
    buffer_store_dwordx2 v[20:21], v41, s[16:19], s45 offen
    s_add_u32 s45, s45, 2304
    v_lshlrev_b32 v8, 16, v222
    v_and_b32 v9, 0xffff0000, v222
    v_and_b32 v4, 0xffff0000, v201
    v_and_b32 v5, 0xffff0000, v205
    v_pk_mul_f32 v[8:9], v[8:9], v[4:5]
    v_cvt_pk_bf16_f32 v22, v8, v9
    v_lshlrev_b32 v10, 16, v223
    v_and_b32 v11, 0xffff0000, v223
    v_and_b32 v6, 0xffff0000, v209
    v_and_b32 v7, 0xffff0000, v213
    v_pk_mul_f32 v[10:11], v[10:11], v[6:7]
    v_cvt_pk_bf16_f32 v23, v10, v11
    buffer_store_dwordx2 v[22:23], v41, s[16:19], s45 offen
    s_add_u32 s45, s45, 2304
    v_lshlrev_b32 v8, 16, v224
    v_and_b32 v9, 0xffff0000, v224
    v_lshlrev_b32 v4, 16, v202
    v_lshlrev_b32 v5, 16, v206
    v_pk_mul_f32 v[8:9], v[8:9], v[4:5]
    v_cvt_pk_bf16_f32 v24, v8, v9
    v_lshlrev_b32 v10, 16, v225
    v_and_b32 v11, 0xffff0000, v225
    v_lshlrev_b32 v6, 16, v210
    v_lshlrev_b32 v7, 16, v214
    v_pk_mul_f32 v[10:11], v[10:11], v[6:7]
    v_cvt_pk_bf16_f32 v25, v10, v11
    buffer_store_dwordx2 v[24:25], v41, s[16:19], s45 offen
    s_add_u32 s45, s45, 2304
    v_lshlrev_b32 v8, 16, v226
    v_and_b32 v9, 0xffff0000, v226
    v_and_b32 v4, 0xffff0000, v202
    v_and_b32 v5, 0xffff0000, v206
    v_pk_mul_f32 v[8:9], v[8:9], v[4:5]
    v_cvt_pk_bf16_f32 v26, v8, v9
    v_lshlrev_b32 v10, 16, v227
    v_and_b32 v11, 0xffff0000, v227
    v_and_b32 v6, 0xffff0000, v210
    v_and_b32 v7, 0xffff0000, v214
    v_pk_mul_f32 v[10:11], v[10:11], v[6:7]
    v_cvt_pk_bf16_f32 v27, v10, v11
    buffer_store_dwordx2 v[26:27], v41, s[16:19], s45 offen
    s_add_u32 s45, s45, 2304
    v_lshlrev_b32 v8, 16, v228
    v_and_b32 v9, 0xffff0000, v228
    v_lshlrev_b32 v4, 16, v203
    v_lshlrev_b32 v5, 16, v207
    v_pk_mul_f32 v[8:9], v[8:9], v[4:5]
    v_cvt_pk_bf16_f32 v28, v8, v9
    v_lshlrev_b32 v10, 16, v229
    v_and_b32 v11, 0xffff0000, v229
    v_lshlrev_b32 v6, 16, v211
    v_lshlrev_b32 v7, 16, v215
    v_pk_mul_f32 v[10:11], v[10:11], v[6:7]
    v_cvt_pk_bf16_f32 v29, v10, v11
    buffer_store_dwordx2 v[28:29], v41, s[16:19], s45 offen
    s_add_u32 s45, s45, 2304
    v_lshlrev_b32 v8, 16, v230
    v_and_b32 v9, 0xffff0000, v230
    v_and_b32 v4, 0xffff0000, v203
    v_and_b32 v5, 0xffff0000, v207
    v_pk_mul_f32 v[8:9], v[8:9], v[4:5]
    v_cvt_pk_bf16_f32 v30, v8, v9
    v_lshlrev_b32 v10, 16, v231
    v_and_b32 v11, 0xffff0000, v231
    v_and_b32 v6, 0xffff0000, v211
    v_and_b32 v7, 0xffff0000, v215
    v_pk_mul_f32 v[10:11], v[10:11], v[6:7]
    v_cvt_pk_bf16_f32 v31, v10, v11
    buffer_store_dwordx2 v[30:31], v41, s[16:19], s45 offen
    s_add_u32 s45, s45, 2304
    s_branch L_endf
L_grpY:
    s_lshr_b32 s40, s2, 3
    s_and_b32 s35, s2, 7
    s_mul_i32 s36, s40, 43
    s_lshr_b32 s36, s36, 8
    s_mul_i32 s34, s36, 6
    s_sub_u32 s34, s40, s34
    s_lshl_b32 s33, s35, 2
    s_add_u32 s33, s33, s36
    s_mul_i32 s45, s34, 192
    s_lshl_b32 s46, s35, 12
    s_add_u32 s46, s46, 14483456
    s_and_b32 s38, s24, 1
    s_bfe_u32 s39, s24, 0x10001
    s_lshl_b32 s35, s33, 1
    s_add_u32 s35, s35, s38
    s_mul_i32 s35, s35, 36864
    s_add_u32 s35, s35, 7340032
    s_lshl_b32 s36, s39, 14
    s_add_u32 s43, s35, s36
    s_lshl_b32 s36, s39, 11
    s_add_u32 s44, s35, s36
    s_add_u32 s44, s44, 0x8000
    v_lshrrev_b32 v150, 5, v250
    v_bfe_u32 v151, v250, 2, 2
    v_and_b32 v152, 3, v250
    v_lshlrev_b32 v152, 3, v152
    v_and_b32 v153, 16, v250
    v_lshl_add_u32 v152, v153, 1, v152
    v_mul_u32_u24 v151, 192, v151
    s_mul_i32 s35, s39, 55296
    v_add3_u32 v152, v152, v151, s35
    v_mul_u32_u24 v151, 768, v150
    v_add_u32 v144, v152, v151
    v_mul_u32_u24 v151, 13824, v150
    v_add_u32 v145, v152, v151
    v_and_b32 v153, 31, v250
    v_lshlrev_b32 v4, 7, v153
    v_lshlrev_b32 v153, 2, v153
    v_lshl_add_u32 v153, v150, 9, v153
    s_waitcnt vmcnt(0)
    v_mov_b32 v150, 163780
    v_mov_b32 v151, 1
    s_mov_b64 exec, 1
    ds_add_rtn_u32 v151, v150, v151
    s_mov_b64 exec, -1
    s_waitcnt lgkmcnt(0)
    v_readfirstlane_b32 s30, v151
    s_cmp_lg_u32 s30, 7
    s_cbranch_scc1 L_sgA3
    s_lshl_b32 s26, s2, 7
    s_add_u32 s26, s26, 14483456
    v_mov_b32 v253, s25
    s_mov_b64 exec, 1
    buffer_store_dword v253, v251, s[8:11], s26 offen sc1
    s_mov_b64 exec, -1
L_sgA3:
    s_cmp_ge_u32 s40, 24
    s_cbranch_scc1 L_endf
    s_cmp_lg_u32 s24, 4
    s_cbranch_scc1 L_p2w
    s_mov_b32 s30, 0
L_s2_poll:
    buffer_load_dword v0, v4, s[8:11], s46 offen sc1
    s_waitcnt vmcnt(0)
    v_xor_b32 v0, s25, v0
    v_cmp_ne_u32 vcc, 0, v0
    s_add_u32 s30, s30, 1
    s_cmp_gt_u32 s30, 65536
    s_cbranch_scc1 L_s2_pdone
    s_cmp_eq_u64 vcc, 0
    s_cbranch_scc1 L_s2_pdone
    s_sleep 2
    s_branch L_s2_poll
L_s2_pdone:
    v_mov_b32 v150, 163804
    v_mov_b32 v151, 1
    s_mov_b64 exec, 1
    ds_add_u32 v150, v151
    s_mov_b64 exec, -1
L_p2w:
    v_mov_b32 v150, 163804
    s_branch L_spF2
L_spF2_s:
    s_sleep 1
L_spF2:
    ds_read_b32 v151, v150
    s_waitcnt lgkmcnt(0)
    v_readfirstlane_b32 s30, v151
    s_cmp_lt_u32 s30, 1
    s_cbranch_scc1 L_spF2_s
    buffer_load_dwordx4 v[0:3], v251, s[8:11], s43 offen offset:0 sc1
    buffer_load_dwordx4 v[4:7], v251, s[8:11], s43 offen offset:1024 sc1
    buffer_load_dwordx4 v[8:11], v251, s[8:11], s43 offen offset:2048 sc1
    buffer_load_dwordx4 v[12:15], v251, s[8:11], s43 offen offset:3072 sc1
    s_add_u32 s43, s43, 4096
    buffer_load_dwordx4 v[16:19], v251, s[8:11], s43 offen offset:0 sc1
    buffer_load_dwordx4 v[20:23], v251, s[8:11], s43 offen offset:1024 sc1
    buffer_load_dwordx4 v[24:27], v251, s[8:11], s43 offen offset:2048 sc1
    buffer_load_dwordx4 v[28:31], v251, s[8:11], s43 offen offset:3072 sc1
    s_add_u32 s43, s43, 4096
    buffer_load_dwordx4 v[32:35], v251, s[8:11], s43 offen offset:0 sc1
    buffer_load_dwordx4 v[36:39], v251, s[8:11], s43 offen offset:1024 sc1
    buffer_load_dwordx4 v[40:43], v251, s[8:11], s43 offen offset:2048 sc1
    buffer_load_dwordx4 v[44:47], v251, s[8:11], s43 offen offset:3072 sc1
    s_add_u32 s43, s43, 4096
    buffer_load_dwordx4 v[48:51], v251, s[8:11], s43 offen offset:0 sc1
    buffer_load_dwordx4 v[52:55], v251, s[8:11], s43 offen offset:1024 sc1
    buffer_load_dwordx4 v[56:59], v251, s[8:11], s43 offen offset:2048 sc1
    buffer_load_dwordx4 v[60:63], v251, s[8:11], s43 offen offset:3072 sc1
    buffer_load_dword v64, v153, s[8:11], s44 offen offset:0 sc1
    buffer_load_dword v65, v153, s[8:11], s44 offen offset:128 sc1
    buffer_load_dword v66, v153, s[8:11], s44 offen offset:256 sc1
    buffer_load_dword v67, v153, s[8:11], s44 offen offset:384 sc1
    buffer_load_dword v68, v153, s[8:11], s44 offen offset:1024 sc1
    buffer_load_dword v69, v153, s[8:11], s44 offen offset:1152 sc1
    buffer_load_dword v70, v153, s[8:11], s44 offen offset:1280 sc1
    buffer_load_dword v71, v153, s[8:11], s44 offen offset:1408 sc1
    v_mov_b32 v150, 163780
    s_branch L_spA2
L_spA2_s:
    s_sleep 1
L_spA2:
    ds_read_b32 v151, v150
    s_waitcnt lgkmcnt(0)
    v_readfirstlane_b32 s30, v151
    s_cmp_lt_u32 s30, 8
    s_cbranch_scc1 L_spA2_s
    ds_read_b64_tr_b16 v[120:121], v144 offset:0
    ds_read_b64_tr_b16 v[122:123], v144 offset:1536
    ds_read_b64_tr_b16 v[124:125], v144 offset:64
    ds_read_b64_tr_b16 v[126:127], v144 offset:1600
    ds_read_b64_tr_b16 v[128:129], v144 offset:128
    ds_read_b64_tr_b16 v[130:131], v144 offset:1664
    ds_read_b64_tr_b16 v[132:133], v144 offset:3840
    ds_read_b64_tr_b16 v[134:135], v144 offset:5376
    ds_read_b64_tr_b16 v[136:137], v144 offset:3904
    ds_read_b64_tr_b16 v[138:139], v144 offset:5440
    ds_read_b64_tr_b16 v[140:141], v144 offset:3968
    ds_read_b64_tr_b16 v[142:143], v144 offset:5504
    s_waitcnt vmcnt(23) lgkmcnt(6)
    v_mfma_f32_32x32x16_bf16 v[72:87], v[120:123], v[0:3], 0
    v_mfma_f32_32x32x16_bf16 v[88:103], v[124:127], v[0:3], 0
    v_mfma_f32_32x32x16_bf16 v[104:119], v[128:131], v[0:3], 0
    ds_read_b64_tr_b16 v[120:121], v144 offset:6912
    ds_read_b64_tr_b16 v[122:123], v144 offset:8448
    ds_read_b64_tr_b16 v[124:125], v144 offset:6976
    ds_read_b64_tr_b16 v[126:127], v144 offset:8512
    ds_read_b64_tr_b16 v[128:129], v144 offset:7040
    ds_read_b64_tr_b16 v[130:131], v144 offset:8576
    s_waitcnt vmcnt(22) lgkmcnt(6)
    v_mfma_f32_32x32x16_bf16 v[72:87], v[132:135], v[4:7], v[72:87]
    v_mfma_f32_32x32x16_bf16 v[88:103], v[136:139], v[4:7], v[88:103]
    v_mfma_f32_32x32x16_bf16 v[104:119], v[140:143], v[4:7], v[104:119]
    ds_read_b64_tr_b16 v[132:133], v144 offset:10752
    ds_read_b64_tr_b16 v[134:135], v144 offset:12288
    ds_read_b64_tr_b16 v[136:137], v144 offset:10816
    ds_read_b64_tr_b16 v[138:139], v144 offset:12352
    ds_read_b64_tr_b16 v[140:141], v144 offset:10880
    ds_read_b64_tr_b16 v[142:143], v144 offset:12416
    s_waitcnt vmcnt(21) lgkmcnt(6)
    v_mfma_f32_32x32x16_bf16 v[72:87], v[120:123], v[8:11], v[72:87]
    v_mfma_f32_32x32x16_bf16 v[88:103], v[124:127], v[8:11], v[88:103]
    v_mfma_f32_32x32x16_bf16 v[104:119], v[128:131], v[8:11], v[104:119]
    ds_read_b64_tr_b16 v[120:121], v144 offset:13824
    ds_read_b64_tr_b16 v[122:123], v144 offset:15360
    ds_read_b64_tr_b16 v[124:125], v144 offset:13888
    ds_read_b64_tr_b16 v[126:127], v144 offset:15424
    ds_read_b64_tr_b16 v[128:129], v144 offset:13952
    ds_read_b64_tr_b16 v[130:131], v144 offset:15488
    s_waitcnt vmcnt(20) lgkmcnt(6)
    v_mfma_f32_32x32x16_bf16 v[72:87], v[132:135], v[12:15], v[72:87]
    v_mfma_f32_32x32x16_bf16 v[88:103], v[136:139], v[12:15], v[88:103]
    v_mfma_f32_32x32x16_bf16 v[104:119], v[140:143], v[12:15], v[104:119]
    ds_read_b64_tr_b16 v[132:133], v144 offset:17664
    ds_read_b64_tr_b16 v[134:135], v144 offset:19200
    ds_read_b64_tr_b16 v[136:137], v144 offset:17728
    ds_read_b64_tr_b16 v[138:139], v144 offset:19264
    ds_read_b64_tr_b16 v[140:141], v144 offset:17792
    ds_read_b64_tr_b16 v[142:143], v144 offset:19328
    s_waitcnt vmcnt(19) lgkmcnt(6)
    v_mfma_f32_32x32x16_bf16 v[72:87], v[120:123], v[16:19], v[72:87]
    v_mfma_f32_32x32x16_bf16 v[88:103], v[124:127], v[16:19], v[88:103]
    v_mfma_f32_32x32x16_bf16 v[104:119], v[128:131], v[16:19], v[104:119]
    ds_read_b64_tr_b16 v[120:121], v144 offset:20736
    ds_read_b64_tr_b16 v[122:123], v144 offset:22272
    ds_read_b64_tr_b16 v[124:125], v144 offset:20800
    ds_read_b64_tr_b16 v[126:127], v144 offset:22336
    ds_read_b64_tr_b16 v[128:129], v144 offset:20864
    ds_read_b64_tr_b16 v[130:131], v144 offset:22400
    s_waitcnt vmcnt(18) lgkmcnt(6)
    v_mfma_f32_32x32x16_bf16 v[72:87], v[132:135], v[20:23], v[72:87]
    v_mfma_f32_32x32x16_bf16 v[88:103], v[136:139], v[20:23], v[88:103]
    v_mfma_f32_32x32x16_bf16 v[104:119], v[140:143], v[20:23], v[104:119]
    ds_read_b64_tr_b16 v[132:133], v144 offset:24576
    ds_read_b64_tr_b16 v[134:135], v144 offset:26112
    ds_read_b64_tr_b16 v[136:137], v144 offset:24640
    ds_read_b64_tr_b16 v[138:139], v144 offset:26176
    ds_read_b64_tr_b16 v[140:141], v144 offset:24704
    ds_read_b64_tr_b16 v[142:143], v144 offset:26240
    s_waitcnt vmcnt(17) lgkmcnt(6)
    v_mfma_f32_32x32x16_bf16 v[72:87], v[120:123], v[24:27], v[72:87]
    v_mfma_f32_32x32x16_bf16 v[88:103], v[124:127], v[24:27], v[88:103]
    v_mfma_f32_32x32x16_bf16 v[104:119], v[128:131], v[24:27], v[104:119]
    ds_read_b64_tr_b16 v[120:121], v144 offset:27648
    ds_read_b64_tr_b16 v[122:123], v144 offset:29184
    ds_read_b64_tr_b16 v[124:125], v144 offset:27712
    ds_read_b64_tr_b16 v[126:127], v144 offset:29248
    ds_read_b64_tr_b16 v[128:129], v144 offset:27776
    ds_read_b64_tr_b16 v[130:131], v144 offset:29312
    s_waitcnt vmcnt(16) lgkmcnt(6)
    v_mfma_f32_32x32x16_bf16 v[72:87], v[132:135], v[28:31], v[72:87]
    v_mfma_f32_32x32x16_bf16 v[88:103], v[136:139], v[28:31], v[88:103]
    v_mfma_f32_32x32x16_bf16 v[104:119], v[140:143], v[28:31], v[104:119]
    ds_read_b64_tr_b16 v[132:133], v144 offset:31488
    ds_read_b64_tr_b16 v[134:135], v144 offset:33024
    ds_read_b64_tr_b16 v[136:137], v144 offset:31552
    ds_read_b64_tr_b16 v[138:139], v144 offset:33088
    ds_read_b64_tr_b16 v[140:141], v144 offset:31616
    ds_read_b64_tr_b16 v[142:143], v144 offset:33152
    s_waitcnt vmcnt(15) lgkmcnt(6)
    v_mfma_f32_32x32x16_bf16 v[72:87], v[120:123], v[32:35], v[72:87]
    v_mfma_f32_32x32x16_bf16 v[88:103], v[124:127], v[32:35], v[88:103]
    v_mfma_f32_32x32x16_bf16 v[104:119], v[128:131], v[32:35], v[104:119]
    ds_read_b64_tr_b16 v[120:121], v144 offset:34560
    ds_read_b64_tr_b16 v[122:123], v144 offset:36096
    ds_read_b64_tr_b16 v[124:125], v144 offset:34624
    ds_read_b64_tr_b16 v[126:127], v144 offset:36160
    ds_read_b64_tr_b16 v[128:129], v144 offset:34688
    ds_read_b64_tr_b16 v[130:131], v144 offset:36224
    s_waitcnt vmcnt(14) lgkmcnt(6)
    v_mfma_f32_32x32x16_bf16 v[72:87], v[132:135], v[36:39], v[72:87]
    v_mfma_f32_32x32x16_bf16 v[88:103], v[136:139], v[36:39], v[88:103]
    v_mfma_f32_32x32x16_bf16 v[104:119], v[140:143], v[36:39], v[104:119]
    ds_read_b64_tr_b16 v[132:133], v144 offset:38400
    ds_read_b64_tr_b16 v[134:135], v144 offset:39936
    ds_read_b64_tr_b16 v[136:137], v144 offset:38464
    ds_read_b64_tr_b16 v[138:139], v144 offset:40000
    ds_read_b64_tr_b16 v[140:141], v144 offset:38528
    ds_read_b64_tr_b16 v[142:143], v144 offset:40064
    s_waitcnt vmcnt(13) lgkmcnt(6)
    v_mfma_f32_32x32x16_bf16 v[72:87], v[120:123], v[40:43], v[72:87]
    v_mfma_f32_32x32x16_bf16 v[88:103], v[124:127], v[40:43], v[88:103]
    v_mfma_f32_32x32x16_bf16 v[104:119], v[128:131], v[40:43], v[104:119]
    ds_read_b64_tr_b16 v[120:121], v144 offset:41472
    ds_read_b64_tr_b16 v[122:123], v144 offset:43008
    ds_read_b64_tr_b16 v[124:125], v144 offset:41536
    ds_read_b64_tr_b16 v[126:127], v144 offset:43072
    ds_read_b64_tr_b16 v[128:129], v144 offset:41600
    ds_read_b64_tr_b16 v[130:131], v144 offset:43136
    s_waitcnt vmcnt(12) lgkmcnt(6)
    v_mfma_f32_32x32x16_bf16 v[72:87], v[132:135], v[44:47], v[72:87]
    v_mfma_f32_32x32x16_bf16 v[88:103], v[136:139], v[44:47], v[88:103]
    v_mfma_f32_32x32x16_bf16 v[104:119], v[140:143], v[44:47], v[104:119]
    ds_read_b64_tr_b16 v[132:133], v144 offset:45312
    ds_read_b64_tr_b16 v[134:135], v144 offset:46848
    ds_read_b64_tr_b16 v[136:137], v144 offset:45376
    ds_read_b64_tr_b16 v[138:139], v144 offset:46912
    ds_read_b64_tr_b16 v[140:141], v144 offset:45440
    ds_read_b64_tr_b16 v[142:143], v144 offset:46976
    s_waitcnt vmcnt(11) lgkmcnt(6)
    v_mfma_f32_32x32x16_bf16 v[72:87], v[120:123], v[48:51], v[72:87]
    v_mfma_f32_32x32x16_bf16 v[88:103], v[124:127], v[48:51], v[88:103]
    v_mfma_f32_32x32x16_bf16 v[104:119], v[128:131], v[48:51], v[104:119]
    ds_read_b64_tr_b16 v[120:121], v144 offset:48384
    ds_read_b64_tr_b16 v[122:123], v144 offset:49920
    ds_read_b64_tr_b16 v[124:125], v144 offset:48448
    ds_read_b64_tr_b16 v[126:127], v144 offset:49984
    ds_read_b64_tr_b16 v[128:129], v144 offset:48512
    ds_read_b64_tr_b16 v[130:131], v144 offset:50048
    s_waitcnt vmcnt(10) lgkmcnt(6)
    v_mfma_f32_32x32x16_bf16 v[72:87], v[132:135], v[52:55], v[72:87]
    v_mfma_f32_32x32x16_bf16 v[88:103], v[136:139], v[52:55], v[88:103]
    v_mfma_f32_32x32x16_bf16 v[104:119], v[140:143], v[52:55], v[104:119]
    ds_read_b64_tr_b16 v[132:133], v144 offset:52224
    ds_read_b64_tr_b16 v[134:135], v144 offset:53760
    ds_read_b64_tr_b16 v[136:137], v144 offset:52288
    ds_read_b64_tr_b16 v[138:139], v144 offset:53824
    ds_read_b64_tr_b16 v[140:141], v144 offset:52352
    ds_read_b64_tr_b16 v[142:143], v144 offset:53888
    s_waitcnt vmcnt(9) lgkmcnt(6)
    v_mfma_f32_32x32x16_bf16 v[72:87], v[120:123], v[56:59], v[72:87]
    v_mfma_f32_32x32x16_bf16 v[88:103], v[124:127], v[56:59], v[88:103]
    v_mfma_f32_32x32x16_bf16 v[104:119], v[128:131], v[56:59], v[104:119]
    ds_read_b64_tr_b16 v[120:121], v145 offset:3072
    ds_read_b64_tr_b16 v[122:123], v145 offset:9984
    ds_read_b64_tr_b16 v[124:125], v145 offset:3136
    ds_read_b64_tr_b16 v[126:127], v145 offset:10048
    ds_read_b64_tr_b16 v[128:129], v145 offset:3200
    ds_read_b64_tr_b16 v[130:131], v145 offset:10112
    s_waitcnt vmcnt(8) lgkmcnt(6)
    v_mfma_f32_32x32x16_bf16 v[72:87], v[132:135], v[60:63], v[72:87]
    v_mfma_f32_32x32x16_bf16 v[88:103], v[136:139], v[60:63], v[88:103]
    v_mfma_f32_32x32x16_bf16 v[104:119], v[140:143], v[60:63], v[104:119]
    ds_read_b64_tr_b16 v[132:133], v145 offset:30720
    ds_read_b64_tr_b16 v[134:135], v145 offset:37632
    ds_read_b64_tr_b16 v[136:137], v145 offset:30784
    ds_read_b64_tr_b16 v[138:139], v145 offset:37696
    ds_read_b64_tr_b16 v[140:141], v145 offset:30848
    ds_read_b64_tr_b16 v[142:143], v145 offset:37760
    s_waitcnt vmcnt(4) lgkmcnt(6)
    v_mfma_f32_32x32x16_bf16 v[72:87], v[120:123], v[64:67], v[72:87]
    v_mfma_f32_32x32x16_bf16 v[88:103], v[124:127], v[64:67], v[88:103]
    v_mfma_f32_32x32x16_bf16 v[104:119], v[128:131], v[64:67], v[104:119]
    s_waitcnt vmcnt(0) lgkmcnt(0)
    v_mfma_f32_32x32x16_bf16 v[72:87], v[132:135], v[68:71], v[72:87]
    v_mfma_f32_32x32x16_bf16 v[88:103], v[136:139], v[68:71], v[88:103]
    v_mfma_f32_32x32x16_bf16 v[104:119], v[140:143], v[68:71], v[104:119]
    s_and_b32 s35, s24, 3
    s_xor_b32 s36, s35, 2
    s_mul_i32 s35, s35, 6144
    s_mul_i32 s36, s36, 6144
    s_add_u32 s35, s35, 122880
    s_add_u32 s36, s36, 122880
    v_add_u32 v150, s35, v251
    v_add_u32 v151, s36, v251
    s_lshl_b32 s35, s38, 2
    s_add_u32 s35, s35, 163796
    v_mov_b32 v152, s35
    v_mov_b32 v153, 1
    s_cmp_eq_u32 s39, 0
    s_cbranch_scc0 L_kh1
    ds_write_b128 v150, v[80:83] offset:0
    ds_write_b128 v150, v[84:87] offset:1024
    ds_write_b128 v150, v[96:99] offset:2048
    ds_write_b128 v150, v[100:103] offset:3072
    ds_write_b128 v150, v[112:115] offset:4096
    ds_write_b128 v150, v[116:119] offset:5120
    s_mov_b64 exec, 1
    ds_add_u32 v152, v153
    s_mov_b64 exec, -1
    s_branch L_spR0
L_spR0_s:
    s_sleep 1
L_spR0:
    ds_read_b32 v153, v152
    s_waitcnt lgkmcnt(0)
    v_readfirstlane_b32 s30, v153
    s_cmp_lt_u32 s30, 2
    s_cbranch_scc1 L_spR0_s
    ds_read_b128 v[0:3], v151 offset:0
    ds_read_b128 v[4:7], v151 offset:1024
    ds_read_b128 v[8:11], v151 offset:2048
    ds_read_b128 v[12:15], v151 offset:3072
    ds_read_b128 v[16:19], v151 offset:4096
    ds_read_b128 v[20:23], v151 offset:5120
    s_waitcnt lgkmcnt(4)
    v_add_f32 v0, v0, v72
    v_add_f32 v1, v1, v73
    v_add_f32 v2, v2, v74
    v_add_f32 v3, v3, v75
    v_add_f32 v4, v4, v76
    v_add_f32 v5, v5, v77
    v_add_f32 v6, v6, v78
    v_add_f32 v7, v7, v79
    s_waitcnt lgkmcnt(2)
    v_add_f32 v8, v8, v88
    v_add_f32 v9, v9, v89
    v_add_f32 v10, v10, v90
    v_add_f32 v11, v11, v91
    v_add_f32 v12, v12, v92
    v_add_f32 v13, v13, v93
    v_add_f32 v14, v14, v94
    v_add_f32 v15, v15, v95
    s_waitcnt lgkmcnt(0)
    v_add_f32 v16, v16, v104
    v_add_f32 v17, v17, v105
    v_add_f32 v18, v18, v106
    v_add_f32 v19, v19, v107
    v_add_f32 v20, v20, v108
    v_add_f32 v21, v21, v109
    v_add_f32 v22, v22, v110
    v_add_f32 v23, v23, v111
    s_branch L_ost
L_kh1:
    ds_write_b128 v150, v[72:75] offset:0
    ds_write_b128 v150, v[76:79] offset:1024
    ds_write_b128 v150, v[88:91] offset:2048
    ds_write_b128 v150, v[92:95] offset:3072
    ds_write_b128 v150, v[104:107] offset:4096
    ds_write_b128 v150, v[108:111] offset:5120
    s_mov_b64 exec, 1
    ds_add_u32 v152, v153
    s_mov_b64 exec, -1
    s_branch L_spR1
L_spR1_s:
    s_sleep 1
L_spR1:
    ds_read_b32 v153, v152
    s_waitcnt lgkmcnt(0)
    v_readfirstlane_b32 s30, v153
    s_cmp_lt_u32 s30, 2
    s_cbranch_scc1 L_spR1_s
    ds_read_b128 v[0:3], v151 offset:0
    ds_read_b128 v[4:7], v151 offset:1024
    ds_read_b128 v[8:11], v151 offset:2048
    ds_read_b128 v[12:15], v151 offset:3072
    ds_read_b128 v[16:19], v151 offset:4096
    ds_read_b128 v[20:23], v151 offset:5120
    s_waitcnt lgkmcnt(4)
    v_add_f32 v0, v0, v80
    v_add_f32 v1, v1, v81
    v_add_f32 v2, v2, v82
    v_add_f32 v3, v3, v83
    v_add_f32 v4, v4, v84
    v_add_f32 v5, v5, v85
    v_add_f32 v6, v6, v86
    v_add_f32 v7, v7, v87
    s_waitcnt lgkmcnt(2)
    v_add_f32 v8, v8, v96
    v_add_f32 v9, v9, v97
    v_add_f32 v10, v10, v98
    v_add_f32 v11, v11, v99
    v_add_f32 v12, v12, v100
    v_add_f32 v13, v13, v101
    v_add_f32 v14, v14, v102
    v_add_f32 v15, v15, v103
    s_waitcnt lgkmcnt(0)
    v_add_f32 v16, v16, v112
    v_add_f32 v17, v17, v113
    v_add_f32 v18, v18, v114
    v_add_f32 v19, v19, v115
    v_add_f32 v20, v20, v116
    v_add_f32 v21, v21, v117
    v_add_f32 v22, v22, v118
    v_add_f32 v23, v23, v119
L_ost:
    v_cvt_pk_bf16_f32 v24, v0, v1
    v_cvt_pk_bf16_f32 v25, v2, v3
    v_cvt_pk_bf16_f32 v26, v4, v5
    v_cvt_pk_bf16_f32 v27, v6, v7
    v_cvt_pk_bf16_f32 v28, v8, v9
    v_cvt_pk_bf16_f32 v29, v10, v11
    v_cvt_pk_bf16_f32 v30, v12, v13
    v_cvt_pk_bf16_f32 v31, v14, v15
    v_cvt_pk_bf16_f32 v32, v16, v17
    v_cvt_pk_bf16_f32 v33, v18, v19
    v_cvt_pk_bf16_f32 v34, v20, v21
    v_cvt_pk_bf16_f32 v35, v22, v23
    v_and_b32 v150, 31, v250
    v_mul_u32_u24 v150, 2304, v150
    v_lshrrev_b32 v151, 5, v250
    v_lshl_add_u32 v150, v151, 4, v150
    s_lshl_b32 s35, s33, 1
    s_add_u32 s35, s35, s38
    s_mul_i32 s35, s35, 73728
    s_lshl_b32 s36, s39, 5
    s_add_u32 s35, s35, s36
    s_add_u32 s35, s35, s45
    v_permlane32_swap_b32 v24, v26
    v_permlane32_swap_b32 v25, v27
    v_permlane32_swap_b32 v28, v30
    v_permlane32_swap_b32 v29, v31
    v_permlane32_swap_b32 v32, v34
    v_permlane32_swap_b32 v33, v35
    buffer_store_dwordx4 v[24:27], v150, s[16:19], s35 offen offset:0
    buffer_store_dwordx4 v[28:31], v150, s[16:19], s35 offen offset:64
    buffer_store_dwordx4 v[32:35], v150, s[16:19], s35 offen offset:128
L_endf:
L_end:
    s_endpgm
L_codeend:
L_slow:
    v_mov_b32 v128, v232
    s_nop 1
    v_permlane32_swap_b32 v232, v128
    s_cmp_lt_u32 s24, 4
    s_cbranch_scc1 L_sl1
    v_mov_b32 v232, v128
    v_mov_b64 v[96:97], v[100:101]
    v_mov_b64 v[98:99], v[102:103]
L_sl1:
    v_mov_b32 v233, 0
    v_mov_b32 v130, 0xff800000
    s_mov_b32 s44, 0
    v_and_b32 v128, 31, v250
    v_lshrrev_b32 v129, 5, v250
    v_mul_u32_u24 v132, 320, v129
    v_and_b32 v129, 3, v128
    v_lshl_add_u32 v132, v129, 1, v132
    v_bfe_u32 v129, v128, 2, 1
    v_lshl_add_u32 v132, v129, 4, v132
    v_bfe_u32 v129, v128, 3, 1
    v_lshl_add_u32 v132, v129, 3, v132
    v_bfe_u32 v129, v128, 4, 1
    v_lshl_add_u32 v132, v129, 5, v132
    v_cmp_gt_u32 vcc, 20, v128
    v_mov_b32 v129, 0x40000000
    v_lshlrev_b32 v133, 2, v250
    v_cndmask_b32 v132, v129, v132, vcc
L_slow_pass:
    s_mov_b32 s37, 0
L_slow_loop:
    s_lshr_b32 s40, s37, 1
    s_mul_i32 s40, s40, 9728
    s_add_u32 s40, s40, s51
    s_and_b32 s41, s37, 1
    s_lshl_b32 s42, s41, 11
    s_add_u32 s42, s42, s40
    s_lshl_b32 s43, s41, 8
    s_add_u32 s43, s43, s40
    s_add_u32 s43, s43, 4096
    s_mul_i32 s41, s41, 2560
    s_add_u32 s41, s41, s40
    s_add_u32 s41, s41, 4608
    buffer_load_dword v234, v133, s[8:11], s43 offen sc1
    buffer_load_dwordx4 v[104:107], v251, s[8:11], s42 offen sc1
    buffer_load_dwordx4 v[108:111], v251, s[8:11], s42 offen offset:1024 sc1
    s_waitcnt vmcnt(0)
    v_mfma_f32_32x32x4_2b_bf16 v[0:31], v[234:235], v[232:233], 0
    s_nop 15
    s_nop 1
    v_mfma_f32_32x32x16_bf16 v[0:15], v[104:107], v[96:99], v[0:15]
    v_mfma_f32_32x32x16_bf16 v[16:31], v[108:111], v[96:99], v[16:31]
    s_nop 11
    s_cmp_eq_u32 s44, 0
    s_cbranch_scc0 L_slow_pv
    v_max3_f32 v130, v130, v0, v1
    v_max3_f32 v130, v130, v2, v3
    v_max3_f32 v130, v130, v4, v5
    v_max3_f32 v130, v130, v6, v7
    v_max3_f32 v130, v130, v8, v9
    v_max3_f32 v130, v130, v10, v11
    v_max3_f32 v130, v130, v12, v13
    v_max3_f32 v130, v130, v14, v15
    v_max3_f32 v130, v130, v16, v17
    v_max3_f32 v130, v130, v18, v19
    v_max3_f32 v130, v130, v20, v21
    v_max3_f32 v130, v130, v22, v23
    v_max3_f32 v130, v130, v24, v25
    v_max3_f32 v130, v130, v26, v27
    v_max3_f32 v130, v130, v28, v29
    v_max3_f32 v130, v130, v30, v31
    s_branch L_slow_nx
L_slow_pv:
    buffer_load_ushort v32, v132, s[8:11], s41 offen offset:0 sc1
    buffer_load_ushort v33, v132, s[8:11], s41 offen offset:40 sc1
    buffer_load_ushort v34, v132, s[8:11], s41 offen offset:80 sc1
    buffer_load_ushort v35, v132, s[8:11], s41 offen offset:120 sc1
    buffer_load_ushort v36, v132, s[8:11], s41 offen offset:160 sc1
    buffer_load_ushort v37, v132, s[8:11], s41 offen offset:200 sc1
    buffer_load_ushort v38, v132, s[8:11], s41 offen offset:240 sc1
    buffer_load_ushort v39, v132, s[8:11], s41 offen offset:280 sc1
    buffer_load_ushort v40, v132, s[8:11], s41 offen offset:640 sc1
    buffer_load_ushort v41, v132, s[8:11], s41 offen offset:680 sc1
    buffer_load_ushort v42, v132, s[8:11], s41 offen offset:720 sc1
    buffer_load_ushort v43, v132, s[8:11], s41 offen offset:760 sc1
    buffer_load_ushort v44, v132, s[8:11], s41 offen offset:800 sc1
    buffer_load_ushort v45, v132, s[8:11], s41 offen offset:840 sc1
    buffer_load_ushort v46, v132, s[8:11], s41 offen offset:880 sc1
    buffer_load_ushort v47, v132, s[8:11], s41 offen offset:920 sc1
    buffer_load_ushort v48, v132, s[8:11], s41 offen offset:1280 sc1
    buffer_load_ushort v49, v132, s[8:11], s41 offen offset:1320 sc1
    buffer_load_ushort v50, v132, s[8:11], s41 offen offset:1360 sc1
    buffer_load_ushort v51, v132, s[8:11], s41 offen offset:1400 sc1
    buffer_load_ushort v52, v132, s[8:11], s41 offen offset:1440 sc1
    buffer_load_ushort v53, v132, s[8:11], s41 offen offset:1480 sc1
    buffer_load_ushort v54, v132, s[8:11], s41 offen offset:1520 sc1
    buffer_load_ushort v55, v132, s[8:11], s41 offen offset:1560 sc1
    buffer_load_ushort v56, v132, s[8:11], s41 offen offset:1920 sc1
    buffer_load_ushort v57, v132, s[8:11], s41 offen offset:1960 sc1
    buffer_load_ushort v58, v132, s[8:11], s41 offen offset:2000 sc1
    buffer_load_ushort v59, v132, s[8:11], s41 offen offset:2040 sc1
    buffer_load_ushort v60, v132, s[8:11], s41 offen offset:2080 sc1
    buffer_load_ushort v61, v132, s[8:11], s41 offen offset:2120 sc1
    buffer_load_ushort v62, v132, s[8:11], s41 offen offset:2160 sc1
    buffer_load_ushort v63, v132, s[8:11], s41 offen offset:2200 sc1
    v_sub_f32 v0, v0, v130
    v_sub_f32 v1, v1, v130
    v_sub_f32 v2, v2, v130
    v_sub_f32 v3, v3, v130
    v_sub_f32 v4, v4, v130
    v_sub_f32 v5, v5, v130
    v_sub_f32 v6, v6, v130
    v_sub_f32 v7, v7, v130
    v_sub_f32 v8, v8, v130
    v_sub_f32 v9, v9, v130
    v_sub_f32 v10, v10, v130
    v_sub_f32 v11, v11, v130
    v_sub_f32 v12, v12, v130
    v_sub_f32 v13, v13, v130
    v_sub_f32 v14, v14, v130
    v_sub_f32 v15, v15, v130
    v_sub_f32 v16, v16, v130
    v_sub_f32 v17, v17, v130
    v_sub_f32 v18, v18, v130
    v_sub_f32 v19, v19, v130
    v_sub_f32 v20, v20, v130
    v_sub_f32 v21, v21, v130
    v_sub_f32 v22, v22, v130
    v_sub_f32 v23, v23, v130
    v_sub_f32 v24, v24, v130
    v_sub_f32 v25, v25, v130
    v_sub_f32 v26, v26, v130
    v_sub_f32 v27, v27, v130
    v_sub_f32 v28, v28, v130
    v_sub_f32 v29, v29, v130
    v_sub_f32 v30, v30, v130
    v_sub_f32 v31, v31, v130
    v_exp_f32 v0, v0
    v_exp_f32 v1, v1
    v_exp_f32 v2, v2
    v_exp_f32 v3, v3
    v_exp_f32 v4, v4
    v_exp_f32 v5, v5
    v_exp_f32 v6, v6
    v_exp_f32 v7, v7
    v_exp_f32 v8, v8
    v_exp_f32 v9, v9
    v_exp_f32 v10, v10
    v_exp_f32 v11, v11
    v_exp_f32 v12, v12
    v_exp_f32 v13, v13
    v_exp_f32 v14, v14
    v_exp_f32 v15, v15
    v_exp_f32 v16, v16
    v_exp_f32 v17, v17
    v_exp_f32 v18, v18
    v_exp_f32 v19, v19
    v_exp_f32 v20, v20
    v_exp_f32 v21, v21
    v_exp_f32 v22, v22
    v_exp_f32 v23, v23
    v_exp_f32 v24, v24
    v_exp_f32 v25, v25
    v_exp_f32 v26, v26
    v_exp_f32 v27, v27
    v_exp_f32 v28, v28
    v_exp_f32 v29, v29
    v_exp_f32 v30, v30
    v_exp_f32 v31, v31
    s_waitcnt vmcnt(0)
    v_lshl_or_b32 v112, v33, 16, v32
    v_lshl_or_b32 v113, v35, 16, v34
    v_lshl_or_b32 v114, v37, 16, v36
    v_lshl_or_b32 v115, v39, 16, v38
    v_lshl_or_b32 v116, v41, 16, v40
    v_lshl_or_b32 v117, v43, 16, v42
    v_lshl_or_b32 v118, v45, 16, v44
    v_lshl_or_b32 v119, v47, 16, v46
    v_lshl_or_b32 v120, v49, 16, v48
    v_lshl_or_b32 v121, v51, 16, v50
    v_lshl_or_b32 v122, v53, 16, v52
    v_lshl_or_b32 v123, v55, 16, v54
    v_lshl_or_b32 v124, v57, 16, v56
    v_lshl_or_b32 v125, v59, 16, v58
    v_lshl_or_b32 v126, v61, 16, v60
    v_lshl_or_b32 v127, v63, 16, v62
    s_nop 1
    v_smfmac_f32_32x32x32_bf16 v[64:79], v[112:115], v[0:7], v236
    v_smfmac_f32_32x32x32_bf16 v[64:79], v[116:119], v[8:15], v236
    v_smfmac_f32_32x32x32_bf16 v[64:79], v[120:123], v[16:23], v236
    v_smfmac_f32_32x32x32_bf16 v[64:79], v[124:127], v[24:31], v236
    s_nop 7
L_slow_nx:
    s_add_u32 s37, s37, 1
    s_cmp_lt_u32 s37, 32
    s_cbranch_scc1 L_slow_loop
    s_cmp_eq_u32 s44, 0
    s_cbranch_scc0 L_slow_done
    v_mov_b32 v129, v130
    s_nop 1
    v_permlane32_swap_b32 v130, v129
    v_max_f32 v130, v130, v129
    v_mov_b32 v64, 0
    v_mov_b32 v65, 0
    v_mov_b32 v66, 0
    v_mov_b32 v67, 0
    v_mov_b32 v68, 0
    v_mov_b32 v69, 0
    v_mov_b32 v70, 0
    v_mov_b32 v71, 0
    v_mov_b32 v72, 0
    v_mov_b32 v73, 0
    v_mov_b32 v74, 0
    v_mov_b32 v75, 0
    v_mov_b32 v76, 0
    v_mov_b32 v77, 0
    v_mov_b32 v78, 0
    v_mov_b32 v79, 0
    s_mov_b32 s44, 1
    s_branch L_slow_pass
L_slow_done:
    s_nop 11
    v_mov_b64 v[16:17], v[64:65]
    v_mov_b64 v[18:19], v[66:67]
    v_mov_b64 v[20:21], v[68:69]
    v_mov_b64 v[22:23], v[70:71]
    v_mov_b64 v[24:25], v[72:73]
    v_mov_b64 v[26:27], v[74:75]
    v_mov_b32 v128, v74
    v_mov_b32 v129, v74
    s_nop 1
    v_permlane32_swap_b32 v128, v129
    s_nop 0
    s_branch L_afin
.section .rodata,"a"
.p2align 6
.amdhsa_kernel concat_heads__softmax_full_mha__ssm_conv_h3__prompt_kernel
  .amdhsa_next_free_vgpr 256
  .amdhsa_next_free_sgpr 102
  .amdhsa_accum_offset 256
  .amdhsa_group_segment_fixed_size 0
  .amdhsa_kernarg_size 96
  .amdhsa_user_sgpr_count 2
  .amdhsa_user_sgpr_kernarg_segment_ptr 1
  .amdhsa_system_sgpr_workgroup_id_x 1
  .amdhsa_float_denorm_mode_32 3
.end_amdhsa_kernel
```
